```python
import torch

def _softmax(x, axis=-1):
    return torch.softmax(x, dim=axis)
def _gelu(x):
    return torch.nn.functional.gelu(x, approximate="tanh")
def _silu(x):
    return torch.nn.functional.silu(x)
def _sigmoid(x):
    return torch.sigmoid(x)
def _layernorm(x, axis=-1, eps=1e-5):
    m = x.mean(dim=axis, keepdim=True)
    v = x.var(dim=axis, keepdim=True, unbiased=False)
    return (x - m) / torch.sqrt(v + eps)
def _scatter_add(tgt, idx, src, axis=0):
    return tgt.clone().index_add_(axis, idx, src)
def _segment_sum(src, seg, n):
    out = torch.zeros((n,) + src.shape[1:], dtype=src.dtype)
    return out.index_add_(0, seg, src)
def _pad(x, pw):
    flat = tuple(v for pair in reversed(pw) for v in pair)
    return torch.nn.functional.pad(x, flat)

kernel_name = 'concat_heads__softmax_full_mha__ssm_conv_s5__prompt'

def setup_inputs():

    _w = (lambda a: (lambda t: t.to(torch.bfloat16) if t.is_floating_point() else t)(torch.as_tensor(a)))
    def _A_setup():
        B, S, D = 1, 2048, 512
        return {
            "x": _w((lambda *s: torch.randn(*s, dtype=torch.bfloat16) * 0.2)(B, S, D)),
            "wqkv": _w((lambda *s: torch.randn(*s, dtype=torch.bfloat16) * 0.2)(D, 3 * D)),
            "wo": _w((lambda *s: torch.randn(*s, dtype=torch.bfloat16) * 0.05)(D, D)),
        }
    _A_in = _A_setup()

    def _B_setup():
        B, S, D = 1, 2048, 512
        P = D
        Lambda_re = -0.5 * (lambda _x: torch.exp(torch.as_tensor(_x)))((lambda *s: torch.randn(*s, dtype=torch.bfloat16) * 0.4)(P))
        Lambda_im = (lambda *s: torch.randn(*s, dtype=torch.bfloat16) * 0.8)(P) * 1.0
        B_re = (lambda *s: torch.randn(*s, dtype=torch.bfloat16) * 0.8)(P, D) * (D ** -0.5)
        B_im = (lambda *s: torch.randn(*s, dtype=torch.bfloat16) * 0.8)(P, D) * (D ** -0.5)
        C_re = (lambda *s: torch.randn(*s, dtype=torch.bfloat16) * 0.8)(D, P) * (P ** -0.5)
        C_im = (lambda *s: torch.randn(*s, dtype=torch.bfloat16) * 0.4)(D, P) * (P ** -0.5)
        log_dt = (lambda *s: torch.randn(*s, dtype=torch.bfloat16) * 0.4)(P) * 0.3 - 2.0
        Dskip = (lambda *s: torch.randn(*s, dtype=torch.bfloat16) * 0.1)(D)
        return {
            "x": _w((lambda *s: torch.randn(*s, dtype=torch.bfloat16) * 0.05)(B, S, D)),
            "Lambda_re": _w(Lambda_re),
            "Lambda_im": _w(Lambda_im),
            "B_re": _w(B_re),
            "B_im": _w(B_im),
            "C_re": _w(C_re),
            "C_im": _w(C_im),
            "log_dt": _w(log_dt),
            "Dskip": _w(Dskip),
        }
    _B_in = _B_setup()

    return {
        "A_x": _A_in["x"],
        "A_wqkv": _A_in["wqkv"],
        "A_wo": _A_in["wo"],
        "B_x": _B_in["x"],
        "B_Lambda_re": _B_in["Lambda_re"],
        "B_Lambda_im": _B_in["Lambda_im"],
        "B_B_re": _B_in["B_re"],
        "B_B_im": _B_in["B_im"],
        "B_C_re": _B_in["C_re"],
        "B_C_im": _B_in["C_im"],
        "B_log_dt": _B_in["log_dt"],
        "B_Dskip": _B_in["Dskip"],
    }

def reference(A_x, A_wqkv, A_wo, B_x, B_Lambda_re, B_Lambda_im, B_B_re, B_B_im, B_C_re, B_C_im, B_log_dt, B_Dskip):
    def _A_ref(x, wqkv, wo):
        B, S, D = x.shape
        H = 32; Dh = D // H
        qkv = (lambda x, *d: x.permute(*d))((x @ wqkv).reshape(B, S, 3, H, Dh), 2, 0, 3, 1, 4)
        q, k, v = qkv[0], qkv[1], qkv[2]
        scale = Dh ** -0.5
        scores = torch.einsum("bhqd,bhkd->bhqk", q, k) * scale
        p = _softmax(scores, axis=-1)
        o = torch.einsum("bhqk,bhkd->bhqd", p, v)
        return (lambda x, *d: x.permute(*d))(o, 0, 2, 1, 3).reshape(B, S, D) @ wo

    def _B_ref(x, Lambda_re, Lambda_im, B_re, B_im, C_re, C_im, log_dt, Dskip):
        Bsz, L, H = x.shape
        Lam = Lambda_re + 1j * Lambda_im
        Bmat = B_re + 1j * B_im
        Cmat = C_re + 1j * C_im
        dt = torch.exp(log_dt)
        Lam_bar = torch.exp(dt * Lam)
        B_bar = ((Lam_bar - 1.0) / Lam)[:, None] * Bmat
        Bu = torch.einsum("bld,pd->blp", x + 0j, B_bar)
        h = torch.zeros_like(Bu[:, 0, :])
        hs = []
        for t in range(L):
            h = Lam_bar[None, :] * h + Bu[:, t, :]
            hs.append(h)
        hseq = torch.stack(hs, 1)
        y = 2.0 * torch.einsum("blp,dp->bld", hseq, Cmat).real + x * Dskip[None, None, :]
        return y

    a = _A_ref(A_x, A_wqkv, A_wo)
    b = _B_ref(B_x, B_Lambda_re, B_Lambda_im, B_B_re, B_B_im, B_C_re, B_C_im, B_log_dt, B_Dskip)
    return torch.concatenate([a, b], axis=-1)
```

```asm
; @launch grid=(256,1,1) block=(768,1,1) lds=163840
.amdgcn_target "amdgcn-amd-amdhsa--gfx950"
.text
.globl concat_heads__softmax_full_mha__ssm_conv_s5__prompt_kernel
.p2align 8
.type concat_heads__softmax_full_mha__ssm_conv_s5__prompt_kernel,@function
concat_heads__softmax_full_mha__ssm_conv_s5__prompt_kernel:
    s_cmp_ge_u32 s2, 256
    s_cbranch_scc1 Lexit
    s_load_dwordx2 s[16:17], s[0:1], 112
    s_load_dwordx2 s[8:9], s[0:1], 0
    s_load_dwordx2 s[12:13], s[0:1], 8
    v_lshrrev_b32 v2, 6, v0
    v_and_b32 v1, 63, v0
    v_readfirstlane_b32 s4, v2
    s_and_b32 s56, s2, 7
    s_bfe_u32 s57, s2, 0x10003
    s_lshl_b32 s5, s57, 3
    s_add_u32 s5, s5, s56
    s_lshr_b32 s6, s2, 4
    s_lshl_b32 s70, s57, 2
    s_add_u32 s70, s70, s6
    s_add_u32 s70, s70, s56
    s_and_b32 s70, s70, 7
    s_lshl_b32 s68, s5, 4
    s_add_u32 s68, s68, s6
    s_mov_b32 s18, 0x1000000
    s_mov_b32 s19, 0x00020000
    s_cmp_lt_u32 s4, 8
    s_cbranch_scc1 Lcompute
Lhelper:
    s_sub_u32 s59, s4, 8
    s_mov_b32 s10, 0x200000
    s_mov_b32 s11, 0x00020000
    s_mov_b32 s14, 0x180000
    s_mov_b32 s15, 0x00020000
    v_lshrrev_b32 v2, 3, v1
    v_lshlrev_b32 v2, 10, v2
    v_lshrrev_b32 v3, 4, v1
    v_and_b32 v4, 7, v1
    v_xor_b32 v14, v3, v4
    v_lshl_add_u32 v7, v14, 4, v2
    v_xor_b32 v14, 4, v14
    v_lshl_add_u32 v8, v14, 4, v2
    v_lshrrev_b32 v14, 2, v1
    v_mul_u32_u24 v15, 3072, v14
    v_and_b32 v11, 3, v1
    v_lshl_add_u32 v5, v11, 4, v15
    v_xor_b32 v12, 2, v11
    v_lshl_add_u32 v6, v12, 4, v15
    s_mul_i32 s60, s59, 49152
    s_lshl_b32 s7, s5, 6
    s_add_u32 s60, s60, s7
    s_lshl_b32 s61, s59, 10
    s_lshl_b32 s62, s6, 17
    s_lshl_b32 s7, s59, 15
    s_add_u32 s62, s62, s7
    s_lshl_b32 s63, s59, 12
    s_add_u32 s63, s63, 98304
    s_waitcnt lgkmcnt(0)
    s_add_u32 s56, s70, 0
    s_and_b32 s56, s56, 7
    s_lshl_b32 s57, s56, 7
    s_add_u32 s57, s57, s62
    s_mul_i32 s56, s56, 196608
    s_add_u32 s56, s56, s60
    s_add_u32 m0, s63, 0
    s_add_u32 s7, s57, 0
    buffer_load_dwordx4 v7, s[8:11], s7 offen lds
    s_add_u32 m0, s63, 1024
    s_add_u32 s7, s57, 8192
    buffer_load_dwordx4 v8, s[8:11], s7 offen lds
    s_add_u32 m0, s63, 2048
    s_add_u32 s7, s57, 16384
    buffer_load_dwordx4 v7, s[8:11], s7 offen lds
    s_add_u32 m0, s63, 3072
    s_add_u32 s7, s57, 24576
    buffer_load_dwordx4 v8, s[8:11], s7 offen lds
    s_add_u32 m0, s61, 0
    s_add_u32 s7, s56, 0
    buffer_load_dwordx4 v5, s[12:15], s7 offen lds
    s_add_u32 m0, s61, 32768
    s_add_u32 s7, s56, 1024
    buffer_load_dwordx4 v6, s[12:15], s7 offen lds
    s_add_u32 m0, s61, 65536
    s_add_u32 s7, s56, 2048
    buffer_load_dwordx4 v5, s[12:15], s7 offen lds
    s_add_u32 s56, s70, 1
    s_and_b32 s56, s56, 7
    s_lshl_b32 s57, s56, 7
    s_add_u32 s57, s57, s62
    s_mul_i32 s56, s56, 196608
    s_add_u32 s56, s56, s60
    s_add_u32 m0, s63, 16384
    s_add_u32 s7, s57, 0
    buffer_load_dwordx4 v7, s[8:11], s7 offen lds
    s_add_u32 m0, s63, 17408
    s_add_u32 s7, s57, 8192
    buffer_load_dwordx4 v8, s[8:11], s7 offen lds
    s_add_u32 m0, s63, 18432
    s_add_u32 s7, s57, 16384
    buffer_load_dwordx4 v7, s[8:11], s7 offen lds
    s_add_u32 m0, s63, 19456
    s_add_u32 s7, s57, 24576
    buffer_load_dwordx4 v8, s[8:11], s7 offen lds
    s_add_u32 m0, s61, 4096
    s_add_u32 s7, s56, 0
    buffer_load_dwordx4 v5, s[12:15], s7 offen lds
    s_add_u32 m0, s61, 36864
    s_add_u32 s7, s56, 1024
    buffer_load_dwordx4 v6, s[12:15], s7 offen lds
    s_add_u32 m0, s61, 69632
    s_add_u32 s7, s56, 2048
    buffer_load_dwordx4 v5, s[12:15], s7 offen lds
    s_load_dwordx2 s[20:21], s[0:1], 96
    s_load_dwordx2 s[24:25], s[0:1], 24
    s_load_dwordx2 s[28:29], s[0:1], 48
    s_load_dwordx2 s[32:33], s[0:1], 56
    s_load_dwordx2 s[36:37], s[0:1], 64
    s_load_dwordx2 s[40:41], s[0:1], 72
    s_load_dwordx2 s[44:45], s[0:1], 16
    s_load_dwordx2 s[48:49], s[0:1], 32
    s_load_dwordx2 s[50:51], s[0:1], 40
    s_load_dwordx2 s[52:53], s[0:1], 80
    s_load_dwordx2 s[54:55], s[0:1], 88
    s_mov_b32 s22, 0x800000
    s_mov_b32 s23, 0x00020000
    s_mov_b32 s26, 0x200000
    s_mov_b32 s27, 0x00020000
    s_mov_b32 s30, 0x80000
    s_mov_b32 s31, 0x00020000
    s_mov_b32 s34, 0x80000
    s_mov_b32 s35, 0x00020000
    s_mov_b32 s38, 0x80000
    s_mov_b32 s39, 0x00020000
    s_mov_b32 s42, 0x80000
    s_mov_b32 s43, 0x00020000
    s_mov_b32 s46, 0x80000
    s_mov_b32 s47, 0x00020000
    v_lshrrev_b32 v2, 2, v1
    v_lshlrev_b32 v2, 10, v2
    v_and_b32 v3, 3, v1
    v_lshl_add_u32 v12, v3, 4, v2
    v_lshlrev_b32 v11, 4, v1
    v_lshrrev_b32 v2, 3, v1
    v_lshlrev_b32 v2, 10, v2
    v_lshrrev_b32 v3, 4, v1
    v_lshlrev_b32 v3, 1, v3
    v_and_b32 v4, 7, v1
    v_xor_b32 v3, v3, v4
    v_lshl_add_u32 v9, v3, 4, v2
    v_xor_b32 v3, 1, v3
    v_lshl_add_u32 v10, v3, 4, v2
    s_waitcnt lgkmcnt(0)
    s_lshl_b32 s64, s5, 17
    s_lshl_b32 s7, s59, 15
    s_add_u32 s64, s64, s7
    s_lshl_b32 s65, s6, 15
    s_lshl_b32 s7, s59, 13
    s_add_u32 s65, s65, s7
    s_lshl_b32 s66, s59, 12
    s_lshl_b32 s67, s59, 10
    v_bfe_u32 v2, v1, 2, 1
    v_lshlrev_b32 v2, 4, v2
    v_and_b32 v3, 3, v1
    v_add_u32 v2, v2, v3
    v_bfe_u32 v3, v1, 3, 2
    v_lshl_add_u32 v2, v3, 2, v2
    v_lshrrev_b32 v3, 1, v2
    v_and_b32 v3, 7, v3
    v_lshrrev_b32 v4, 5, v1
    v_xor_b32 v3, v3, v4
    s_lshl_b32 s7, s59, 12
    s_add_u32 s7, s7, 65536
    v_lshlrev_b32 v2, 7, v2
    v_add_u32 v2, s7, v2
    v_xor_b32 v4, 0, v3
    v_lshl_add_u32 v16, v4, 4, v2
    v_add_u32 v24, 57344, v16
    v_xor_b32 v4, 2, v3
    v_lshl_add_u32 v17, v4, 4, v2
    v_add_u32 v25, 57344, v17
    v_xor_b32 v4, 4, v3
    v_lshl_add_u32 v18, v4, 4, v2
    v_add_u32 v26, 57344, v18
    v_xor_b32 v4, 6, v3
    v_lshl_add_u32 v19, v4, 4, v2
    v_add_u32 v27, 57344, v19
    v_bfe_u32 v2, v1, 1, 4
    v_bfe_u32 v3, v1, 2, 2
    v_lshlrev_b32 v3, 1, v3
    v_and_b32 v4, 1, v1
    v_or_b32 v3, v3, v4
    v_lshlrev_b32 v2, 7, v2
    v_lshl_add_u32 v2, v4, 12, v2
    v_lshrrev_b32 v4, 5, v1
    v_xor_b32 v3, v3, v4
    v_add_u32 v2, 81920, v2
    v_xor_b32 v4, 0, v3
    v_lshl_add_u32 v20, v4, 4, v2
    v_xor_b32 v4, 2, v3
    v_lshl_add_u32 v21, v4, 4, v2
    v_xor_b32 v4, 4, v3
    v_lshl_add_u32 v22, v4, 4, v2
    v_xor_b32 v4, 6, v3
    v_lshl_add_u32 v23, v4, 4, v2
    v_and_b32 v2, 31, v1
    v_lshrrev_b32 v3, 1, v2
    v_and_b32 v3, 7, v3
    v_lshrrev_b32 v4, 5, v1
    v_xor_b32 v3, v3, v4
    s_lshr_b32 s7, s59, 1
    s_lshl_b32 s7, s7, 2
    v_xor_b32 v3, s7, v3
    s_and_b32 s7, s6, 1
    s_lshl_b32 s7, s7, 1
    s_and_b32 s56, s59, 1
    s_add_u32 s7, s7, s56
    s_lshl_b32 s7, s7, 12
    s_add_u32 s7, s7, 65536
    v_lshlrev_b32 v2, 7, v2
    v_add_u32 v2, s7, v2
    v_xor_b32 v4, 0, v3
    v_lshl_add_u32 v28, v4, 4, v2
    v_add_u32 v30, 57344, v28
    v_xor_b32 v4, 2, v3
    v_lshl_add_u32 v29, v4, 4, v2
    v_add_u32 v31, 57344, v29
    s_lshr_b32 s68, s6, 1
    s_sub_u32 s68, s68, s70
    s_and_b32 s68, s68, 7
    s_waitcnt vmcnt(7)
    s_barrier
    s_add_u32 s56, s70, 2
    s_and_b32 s56, s56, 7
    s_lshl_b32 s57, s56, 7
    s_add_u32 s57, s57, s62
    s_mul_i32 s56, s56, 196608
    s_add_u32 s56, s56, s60
    s_add_u32 m0, s63, 32768
    s_add_u32 s7, s57, 0
    buffer_load_dwordx4 v7, s[8:11], s7 offen lds
    s_add_u32 m0, s63, 33792
    s_add_u32 s7, s57, 8192
    buffer_load_dwordx4 v8, s[8:11], s7 offen lds
    s_add_u32 m0, s63, 34816
    s_add_u32 s7, s57, 16384
    buffer_load_dwordx4 v7, s[8:11], s7 offen lds
    s_add_u32 m0, s63, 35840
    s_add_u32 s7, s57, 24576
    buffer_load_dwordx4 v8, s[8:11], s7 offen lds
    s_add_u32 m0, s61, 8192
    s_add_u32 s7, s56, 0
    buffer_load_dwordx4 v5, s[12:15], s7 offen lds
    s_add_u32 m0, s61, 40960
    s_add_u32 s7, s56, 1024
    buffer_load_dwordx4 v6, s[12:15], s7 offen lds
    s_add_u32 m0, s61, 73728
    s_add_u32 s7, s56, 2048
    buffer_load_dwordx4 v5, s[12:15], s7 offen lds
    s_waitcnt vmcnt(7)
    s_barrier
    s_add_u32 s56, s70, 3
    s_and_b32 s56, s56, 7
    s_lshl_b32 s57, s56, 7
    s_add_u32 s57, s57, s62
    s_mul_i32 s56, s56, 196608
    s_add_u32 s56, s56, s60
    s_add_u32 m0, s63, 49152
    s_add_u32 s7, s57, 0
    buffer_load_dwordx4 v7, s[8:11], s7 offen lds
    s_add_u32 m0, s63, 50176
    s_add_u32 s7, s57, 8192
    buffer_load_dwordx4 v8, s[8:11], s7 offen lds
    s_add_u32 m0, s63, 51200
    s_add_u32 s7, s57, 16384
    buffer_load_dwordx4 v7, s[8:11], s7 offen lds
    s_add_u32 m0, s63, 52224
    s_add_u32 s7, s57, 24576
    buffer_load_dwordx4 v8, s[8:11], s7 offen lds
    s_add_u32 m0, s61, 12288
    s_add_u32 s7, s56, 0
    buffer_load_dwordx4 v5, s[12:15], s7 offen lds
    s_add_u32 m0, s61, 45056
    s_add_u32 s7, s56, 1024
    buffer_load_dwordx4 v6, s[12:15], s7 offen lds
    s_add_u32 m0, s61, 77824
    s_add_u32 s7, s56, 2048
    buffer_load_dwordx4 v5, s[12:15], s7 offen lds
    s_waitcnt vmcnt(7)
    s_barrier
    s_add_u32 s56, s70, 4
    s_and_b32 s56, s56, 7
    s_lshl_b32 s57, s56, 7
    s_add_u32 s57, s57, s62
    s_mul_i32 s56, s56, 196608
    s_add_u32 s56, s56, s60
    s_add_u32 m0, s63, 0
    s_add_u32 s7, s57, 0
    buffer_load_dwordx4 v7, s[8:11], s7 offen lds
    s_add_u32 m0, s63, 1024
    s_add_u32 s7, s57, 8192
    buffer_load_dwordx4 v8, s[8:11], s7 offen lds
    s_add_u32 m0, s63, 2048
    s_add_u32 s7, s57, 16384
    buffer_load_dwordx4 v7, s[8:11], s7 offen lds
    s_add_u32 m0, s63, 3072
    s_add_u32 s7, s57, 24576
    buffer_load_dwordx4 v8, s[8:11], s7 offen lds
    s_add_u32 m0, s61, 16384
    s_add_u32 s7, s56, 0
    buffer_load_dwordx4 v5, s[12:15], s7 offen lds
    s_add_u32 m0, s61, 49152
    s_add_u32 s7, s56, 1024
    buffer_load_dwordx4 v6, s[12:15], s7 offen lds
    s_add_u32 m0, s61, 81920
    s_add_u32 s7, s56, 2048
    buffer_load_dwordx4 v5, s[12:15], s7 offen lds
    s_waitcnt vmcnt(7)
    s_barrier
    s_add_u32 s56, s70, 5
    s_and_b32 s56, s56, 7
    s_lshl_b32 s57, s56, 7
    s_add_u32 s57, s57, s62
    s_mul_i32 s56, s56, 196608
    s_add_u32 s56, s56, s60
    s_add_u32 m0, s63, 16384
    s_add_u32 s7, s57, 0
    buffer_load_dwordx4 v7, s[8:11], s7 offen lds
    s_add_u32 m0, s63, 17408
    s_add_u32 s7, s57, 8192
    buffer_load_dwordx4 v8, s[8:11], s7 offen lds
    s_add_u32 m0, s63, 18432
    s_add_u32 s7, s57, 16384
    buffer_load_dwordx4 v7, s[8:11], s7 offen lds
    s_add_u32 m0, s63, 19456
    s_add_u32 s7, s57, 24576
    buffer_load_dwordx4 v8, s[8:11], s7 offen lds
    s_add_u32 m0, s61, 20480
    s_add_u32 s7, s56, 0
    buffer_load_dwordx4 v5, s[12:15], s7 offen lds
    s_add_u32 m0, s61, 53248
    s_add_u32 s7, s56, 1024
    buffer_load_dwordx4 v6, s[12:15], s7 offen lds
    s_add_u32 m0, s61, 86016
    s_add_u32 s7, s56, 2048
    buffer_load_dwordx4 v5, s[12:15], s7 offen lds
    s_waitcnt vmcnt(7)
    s_barrier
    s_add_u32 s56, s70, 6
    s_and_b32 s56, s56, 7
    s_lshl_b32 s57, s56, 7
    s_add_u32 s57, s57, s62
    s_mul_i32 s56, s56, 196608
    s_add_u32 s56, s56, s60
    s_add_u32 m0, s63, 32768
    s_add_u32 s7, s57, 0
    buffer_load_dwordx4 v7, s[8:11], s7 offen lds
    s_add_u32 m0, s63, 33792
    s_add_u32 s7, s57, 8192
    buffer_load_dwordx4 v8, s[8:11], s7 offen lds
    s_add_u32 m0, s63, 34816
    s_add_u32 s7, s57, 16384
    buffer_load_dwordx4 v7, s[8:11], s7 offen lds
    s_add_u32 m0, s63, 35840
    s_add_u32 s7, s57, 24576
    buffer_load_dwordx4 v8, s[8:11], s7 offen lds
    s_add_u32 m0, s61, 24576
    s_add_u32 s7, s56, 0
    buffer_load_dwordx4 v5, s[12:15], s7 offen lds
    s_add_u32 m0, s61, 57344
    s_add_u32 s7, s56, 1024
    buffer_load_dwordx4 v6, s[12:15], s7 offen lds
    s_add_u32 m0, s61, 90112
    s_add_u32 s7, s56, 2048
    buffer_load_dwordx4 v5, s[12:15], s7 offen lds
    s_waitcnt vmcnt(7)
    s_barrier
    s_add_u32 s56, s70, 7
    s_and_b32 s56, s56, 7
    s_lshl_b32 s57, s56, 7
    s_add_u32 s57, s57, s62
    s_mul_i32 s56, s56, 196608
    s_add_u32 s56, s56, s60
    s_add_u32 m0, s63, 49152
    s_add_u32 s7, s57, 0
    buffer_load_dwordx4 v7, s[8:11], s7 offen lds
    s_add_u32 m0, s63, 50176
    s_add_u32 s7, s57, 8192
    buffer_load_dwordx4 v8, s[8:11], s7 offen lds
    s_add_u32 m0, s63, 51200
    s_add_u32 s7, s57, 16384
    buffer_load_dwordx4 v7, s[8:11], s7 offen lds
    s_add_u32 m0, s63, 52224
    s_add_u32 s7, s57, 24576
    buffer_load_dwordx4 v8, s[8:11], s7 offen lds
    s_add_u32 m0, s61, 28672
    s_add_u32 s7, s56, 0
    buffer_load_dwordx4 v5, s[12:15], s7 offen lds
    s_add_u32 m0, s61, 61440
    s_add_u32 s7, s56, 1024
    buffer_load_dwordx4 v6, s[12:15], s7 offen lds
    s_add_u32 m0, s61, 94208
    s_add_u32 s7, s56, 2048
    buffer_load_dwordx4 v5, s[12:15], s7 offen lds
    v_mov_b32 v147, 0
    s_mov_b32 s7, 13631488
    buffer_load_dword v146, v147, s[16:19], s7 offen sc1
    s_waitcnt vmcnt(8)
    s_barrier
    s_add_u32 s56, s70, 0
    s_and_b32 s56, s56, 7
    s_lshl_b32 s56, s56, 7
    s_add_u32 s57, s56, s64
    s_add_u32 s56, s56, s65
    s_add_u32 m0, s66, 65536
    s_add_u32 s7, s57, 0
    buffer_load_dwordx4 v7, s[24:27], s7 offen lds
    s_add_u32 m0, s66, 66560
    s_add_u32 s7, s57, 8192
    buffer_load_dwordx4 v8, s[24:27], s7 offen lds
    s_add_u32 m0, s66, 67584
    s_add_u32 s7, s57, 16384
    buffer_load_dwordx4 v7, s[24:27], s7 offen lds
    s_add_u32 m0, s66, 68608
    s_add_u32 s7, s57, 24576
    buffer_load_dwordx4 v8, s[24:27], s7 offen lds
    s_add_u32 s74, s70, 1
    s_and_b32 s74, s74, 7
    s_lshl_b32 s74, s74, 7
    s_add_u32 s75, s74, s64
    s_add_u32 s74, s74, s65
    s_add_u32 m0, s66, 98304
    s_add_u32 s7, s75, 0
    buffer_load_dwordx4 v7, s[24:27], s7 offen lds
    s_add_u32 m0, s66, 99328
    s_add_u32 s7, s75, 8192
    buffer_load_dwordx4 v8, s[24:27], s7 offen lds
    s_add_u32 m0, s66, 100352
    s_add_u32 s7, s75, 16384
    buffer_load_dwordx4 v7, s[24:27], s7 offen lds
    s_add_u32 m0, s66, 101376
    s_add_u32 s7, s75, 24576
    buffer_load_dwordx4 v8, s[24:27], s7 offen lds
    s_waitcnt vmcnt(9)
    s_barrier
    v_mov_b32 v15, 0
    ds_read_b32 v14, v15
    s_add_u32 s56, s70, 0
    s_and_b32 s56, s56, 7
    s_lshl_b32 s56, s56, 7
    s_add_u32 s57, s56, s64
    s_add_u32 s56, s56, s65
    s_add_u32 m0, s67, 81920
    s_add_u32 s7, s56, 0
    buffer_load_dwordx4 v9, s[28:31], s7 offen lds
    s_add_u32 m0, s67, 86016
    s_add_u32 s7, s56, 0
    buffer_load_dwordx4 v10, s[32:35], s7 offen lds
    s_add_u32 s74, s70, 1
    s_and_b32 s74, s74, 7
    s_lshl_b32 s74, s74, 7
    s_add_u32 s75, s74, s64
    s_add_u32 s74, s74, s65
    s_add_u32 m0, s67, 114688
    s_add_u32 s7, s74, 0
    buffer_load_dwordx4 v9, s[28:31], s7 offen lds
    s_add_u32 m0, s67, 118784
    s_add_u32 s7, s74, 0
    buffer_load_dwordx4 v10, s[32:35], s7 offen lds
    s_waitcnt lgkmcnt(0)
    v_readfirstlane_b32 s3, v14
    s_waitcnt vmcnt(12)
    v_readfirstlane_b32 s69, v146
    s_nop 3
    s_add_u32 s69, s69, 0x61c88647
    v_bfe_u32 v99, v1, 1, 4
    v_lshrrev_b32 v100, 5, v1
    v_lshl_add_u32 v99, v100, 4, v99
    s_lshl_b32 s7, s6, 5
    v_add_u32 v99, s7, v99
    v_lshlrev_b32 v99, 1, v99
    global_load_ushort v96, v99, s[48:49]
    global_load_ushort v97, v99, s[50:51]
    global_load_ushort v98, v99, s[52:53]
    s_barrier
    s_barrier
    s_waitcnt vmcnt(2)
    v_lshlrev_b32 v96, 16, v96
    s_waitcnt vmcnt(1)
    v_lshlrev_b32 v97, 16, v97
    s_waitcnt vmcnt(0)
    v_lshlrev_b32 v98, 16, v98
    v_mul_f32 v99, 0x3fb8aa3b, v98
    v_exp_f32 v99, v99
    s_nop 0
    v_cvt_pk_bf16_f32 v99, v99, v99
    v_and_b32 v99, 0xffff0000, v99
    v_mul_f32 v100, v99, v96
    v_mul_f32 v101, v99, v97
    v_mul_f32 v100, 0x3fb8aa3b, v100
    v_exp_f32 v100, v100
    v_mul_f32 v101, 0.15915494309189535, v101
    v_fract_f32 v101, v101
    v_cos_f32 v102, v101
    v_sin_f32 v101, v101
    v_mul_f32 v105, v100, v102
    v_mul_f32 v101, v100, v101
    v_add_f32 v99, -1.0, v105
    v_mul_f32 v100, v96, v96
    v_fmac_f32 v100, v97, v97
    v_rcp_f32 v100, v100
    v_mul_f32 v102, v99, v96
    v_fmac_f32 v102, v101, v97
    v_mul_f32 v98, v101, v96
    v_fma_f32 v98, -v99, v97, v98
    v_mul_f32 v102, v102, v100
    v_mul_f32 v98, v98, v100
    v_and_b32 v99, 1, v1
    v_cmp_eq_u32 vcc, 1, v99
    v_sub_f32 v100, 0, v101
    s_nop 0
    v_cndmask_b32 v107, v100, v101, vcc
    v_add_f32 v102, v102, v102
    v_sub_f32 v100, 0, v102
    v_cndmask_b32 v113, v102, v100, vcc
    v_mul_f32 v115, -2.0, v98
    v_mov_b32 v99, v105
    v_mul_f32 v100, v99, v101
    v_mul_f32 v102, v101, v101
    v_fma_f32 v99, v99, v99, -v102
    v_add_f32 v101, v100, v100
    v_mul_f32 v100, v99, v101
    v_mul_f32 v102, v101, v101
    v_fma_f32 v99, v99, v99, -v102
    v_add_f32 v101, v100, v100
    v_mul_f32 v100, v99, v101
    v_mul_f32 v102, v101, v101
    v_fma_f32 v99, v99, v99, -v102
    v_add_f32 v101, v100, v100
    v_mul_f32 v100, v99, v101
    v_mul_f32 v102, v101, v101
    v_fma_f32 v99, v99, v99, -v102
    v_add_f32 v101, v100, v100
    v_mov_b32 v109, v99
    v_sub_f32 v100, 0, v101
    v_cndmask_b32 v111, v100, v101, vcc
    v_mov_b32 v152, v99
    v_mov_b32 v153, v101
    v_mul_f32 v100, v99, v101
    v_mul_f32 v102, v101, v101
    v_fma_f32 v99, v99, v99, -v102
    v_add_f32 v101, v100, v100
    v_mov_b32 v163, v99
    v_mov_b32 v164, v101
    v_mul_f32 v100, v99, v101
    v_mul_f32 v102, v101, v101
    v_fma_f32 v99, v99, v99, -v102
    v_add_f32 v101, v100, v100
    v_mov_b32 v165, v99
    v_mov_b32 v166, v101
    v_mul_f32 v100, v99, v101
    v_mul_f32 v102, v101, v101
    v_fma_f32 v99, v99, v99, -v102
    v_add_f32 v101, v100, v100
    v_mov_b32 v103, v99
    v_sub_f32 v100, 0, v101
    v_cndmask_b32 v104, v100, v101, vcc
    s_bitcmp1_b32 s59, 0
    s_cselect_b64 s[74:75], -1, 0
    v_cndmask_b32 v148, 1.0, v163, s[74:75]
    v_cndmask_b32 v149, 0, v164, s[74:75]
    s_bitcmp1_b32 s59, 1
    s_cselect_b64 s[74:75], -1, 0
    v_cndmask_b32 v165, 1.0, v165, s[74:75]
    v_cndmask_b32 v166, 0, v166, s[74:75]
    v_mul_f32 v100, v149, v166
    v_mul_f32 v102, v148, v166
    v_fma_f32 v99, v148, v165, -v100
    v_fma_f32 v149, v149, v165, v102
    v_mov_b32 v148, v99
    v_mul_f32 v100, v149, v153
    v_mul_f32 v102, v148, v153
    v_fma_f32 v99, v148, v152, -v100
    v_fma_f32 v151, v149, v152, v102
    v_mov_b32 v150, v99
    v_mov_b32 v163, v148
    v_mov_b32 v164, v163
    s_nop 1
    v_permlane32_swap_b32 v163, v164
    v_mov_b32 v165, v149
    v_mov_b32 v166, v165
    s_nop 1
    v_permlane32_swap_b32 v165, v166
    v_mov_b32 v152, v150
    v_mov_b32 v153, v152
    s_nop 1
    v_permlane32_swap_b32 v152, v153
    v_mov_b32 v154, v151
    v_mov_b32 v155, v154
    s_nop 1
    v_permlane32_swap_b32 v154, v155
    v_lshrrev_b32 v99, 5, v1
    v_cmp_eq_u32 s[74:75], 1, v99
    s_nop 1
    v_cndmask_b32 v158, v163, v152, s[74:75]
    v_cndmask_b32 v100, v165, v154, s[74:75]
    v_sub_f32 v102, 0, v100
    v_cndmask_b32 v160, v102, v100, vcc
    v_cndmask_b32 v159, v164, v153, s[74:75]
    v_cndmask_b32 v100, v166, v155, s[74:75]
    v_sub_f32 v102, 0, v100
    v_cndmask_b32 v161, v102, v100, vcc
    v_mov_b32 v106, v105
    s_nop 1
    v_permlane32_swap_b32 v105, v106
    v_mov_b32 v108, v107
    s_nop 1
    v_permlane32_swap_b32 v107, v108
    v_mov_b32 v110, v109
    s_nop 1
    v_permlane32_swap_b32 v109, v110
    v_mov_b32 v112, v111
    s_nop 1
    v_permlane32_swap_b32 v111, v112
    v_mov_b32 v114, v113
    s_nop 1
    v_permlane32_swap_b32 v113, v114
    v_mov_b32 v116, v115
    s_nop 1
    v_permlane32_swap_b32 v115, v116
    s_barrier
    s_setprio 1
    s_add_u32 s56, s70, 2
    s_and_b32 s56, s56, 7
    s_lshl_b32 s56, s56, 7
    s_add_u32 s57, s56, s64
    s_add_u32 s56, s56, s65
    s_add_u32 m0, s66, 122880
    s_add_u32 s7, s57, 0
    buffer_load_dwordx4 v7, s[24:27], s7 offen lds
    s_cmp_lg_u32 s68, 0
    s_cbranch_scc1 Lnosk_2
    ds_read_b128 v[148:151], v28 offset:0
    ds_read_b128 v[152:155], v29 offset:0
    s_waitcnt lgkmcnt(0)
Lnosk_2:
    s_cmp_lg_u32 s68, 1
    s_cbranch_scc1 Lnosk_3
    ds_read_b128 v[148:151], v28 offset:32768
    ds_read_b128 v[152:155], v29 offset:32768
    s_waitcnt lgkmcnt(0)
Lnosk_3:
    ds_read_b128 v[36:39], v16 offset:0
    ds_read_b128 v[44:47], v20 offset:0
    ds_read_b128 v[48:51], v20 offset:2048
    ds_read_b128 v[40:43], v17 offset:0
    ds_read_b128 v[52:55], v21 offset:0
    ds_read_b128 v[56:59], v21 offset:2048
    s_add_u32 m0, s66, 123904
    s_add_u32 s7, s57, 8192
    buffer_load_dwordx4 v8, s[24:27], s7 offen lds
    s_waitcnt lgkmcnt(4)
    v_mfma_f32_32x32x16_bf16 v[64:79], v[36:39], v[44:47], 0
    s_waitcnt lgkmcnt(3)
    v_mfma_f32_32x32x16_bf16 v[80:95], v[36:39], v[48:51], 0
    ds_read_b128 v[36:39], v18 offset:0
    ds_read_b128 v[44:47], v22 offset:0
    ds_read_b128 v[48:51], v22 offset:2048
    s_add_u32 m0, s66, 124928
    s_add_u32 s7, s57, 16384
    buffer_load_dwordx4 v7, s[24:27], s7 offen lds
    s_waitcnt lgkmcnt(4)
    v_mfma_f32_32x32x16_bf16 v[64:79], v[40:43], v[52:55], v[64:79]
    s_waitcnt lgkmcnt(3)
    v_mfma_f32_32x32x16_bf16 v[80:95], v[40:43], v[56:59], v[80:95]
    ds_read_b128 v[40:43], v19 offset:0
    ds_read_b128 v[52:55], v23 offset:0
    ds_read_b128 v[56:59], v23 offset:2048
    s_add_u32 m0, s66, 125952
    s_add_u32 s7, s57, 24576
    buffer_load_dwordx4 v8, s[24:27], s7 offen lds
    s_add_u32 m0, s67, 139264
    s_add_u32 s7, s56, 0
    buffer_load_dwordx4 v9, s[28:31], s7 offen lds
    s_waitcnt lgkmcnt(4)
    v_mfma_f32_32x32x16_bf16 v[64:79], v[36:39], v[44:47], v[64:79]
    s_waitcnt lgkmcnt(3)
    v_mfma_f32_32x32x16_bf16 v[80:95], v[36:39], v[48:51], v[80:95]
    ds_read_b128 v[36:39], v16 offset:32768
    ds_read_b128 v[44:47], v20 offset:32768
    ds_read_b128 v[48:51], v20 offset:34816
    s_add_u32 m0, s67, 143360
    s_add_u32 s7, s56, 0
    buffer_load_dwordx4 v10, s[32:35], s7 offen lds
    s_waitcnt lgkmcnt(4)
    v_mfma_f32_32x32x16_bf16 v[64:79], v[40:43], v[52:55], v[64:79]
    s_waitcnt lgkmcnt(3)
    v_mfma_f32_32x32x16_bf16 v[80:95], v[40:43], v[56:59], v[80:95]
    ds_read_b128 v[40:43], v17 offset:32768
    ds_read_b128 v[52:55], v21 offset:32768
    ds_read_b128 v[56:59], v21 offset:34816
    s_add_u32 s74, s70, 3
    s_and_b32 s74, s74, 7
    s_lshl_b32 s74, s74, 7
    s_add_u32 s75, s74, s64
    s_add_u32 s74, s74, s65
    s_add_u32 m0, s66, 147456
    s_add_u32 s7, s75, 0
    buffer_load_dwordx4 v7, s[24:27], s7 offen lds
    s_waitcnt lgkmcnt(4)
    v_mfma_f32_32x32x16_bf16 v[64:79], v[36:39], v[44:47], v[64:79]
    s_waitcnt lgkmcnt(3)
    v_mfma_f32_32x32x16_bf16 v[80:95], v[36:39], v[48:51], v[80:95]
    ds_read_b128 v[36:39], v18 offset:32768
    ds_read_b128 v[44:47], v22 offset:32768
    ds_read_b128 v[48:51], v22 offset:34816
    s_add_u32 m0, s66, 148480
    s_add_u32 s7, s75, 8192
    buffer_load_dwordx4 v8, s[24:27], s7 offen lds
    s_add_u32 m0, s66, 149504
    s_add_u32 s7, s75, 16384
    buffer_load_dwordx4 v7, s[24:27], s7 offen lds
    s_waitcnt lgkmcnt(4)
    v_mfma_f32_32x32x16_bf16 v[64:79], v[40:43], v[52:55], v[64:79]
    s_waitcnt lgkmcnt(3)
    v_mfma_f32_32x32x16_bf16 v[80:95], v[40:43], v[56:59], v[80:95]
    ds_read_b128 v[40:43], v19 offset:32768
    ds_read_b128 v[52:55], v23 offset:32768
    ds_read_b128 v[56:59], v23 offset:34816
    s_add_u32 m0, s66, 150528
    s_add_u32 s7, s75, 24576
    buffer_load_dwordx4 v8, s[24:27], s7 offen lds
    s_waitcnt lgkmcnt(4)
    v_mfma_f32_32x32x16_bf16 v[64:79], v[36:39], v[44:47], v[64:79]
    s_waitcnt lgkmcnt(3)
    v_mfma_f32_32x32x16_bf16 v[80:95], v[36:39], v[48:51], v[80:95]
    s_add_u32 m0, s67, 90112
    s_add_u32 s7, s74, 0
    buffer_load_dwordx4 v9, s[28:31], s7 offen lds
    s_waitcnt lgkmcnt(1)
    v_mfma_f32_32x32x16_bf16 v[64:79], v[40:43], v[52:55], v[64:79]
    s_waitcnt lgkmcnt(0)
    v_mfma_f32_32x32x16_bf16 v[80:95], v[40:43], v[56:59], v[80:95]
    s_add_u32 m0, s67, 94208
    s_add_u32 s7, s74, 0
    buffer_load_dwordx4 v10, s[32:35], s7 offen lds
    s_barrier
    s_add_u32 s56, s70, 4
    s_and_b32 s56, s56, 7
    s_lshl_b32 s56, s56, 7
    s_add_u32 s57, s56, s64
    s_add_u32 s56, s56, s65
    s_add_u32 m0, s66, 65536
    s_add_u32 s7, s57, 0
    buffer_load_dwordx4 v7, s[24:27], s7 offen lds
    s_add_u32 m0, s66, 66560
    s_add_u32 s7, s57, 8192
    buffer_load_dwordx4 v8, s[24:27], s7 offen lds
    s_add_u32 m0, s66, 67584
    s_add_u32 s7, s57, 16384
    buffer_load_dwordx4 v7, s[24:27], s7 offen lds
    s_add_u32 m0, s66, 68608
    s_add_u32 s7, s57, 24576
    buffer_load_dwordx4 v8, s[24:27], s7 offen lds
    s_add_u32 m0, s67, 81920
    s_add_u32 s7, s56, 0
    buffer_load_dwordx4 v9, s[28:31], s7 offen lds
    s_add_u32 m0, s67, 86016
    s_add_u32 s7, s56, 0
    buffer_load_dwordx4 v10, s[32:35], s7 offen lds
    s_add_u32 s74, s70, 5
    s_and_b32 s74, s74, 7
    s_lshl_b32 s74, s74, 7
    s_add_u32 s75, s74, s64
    s_add_u32 s74, s74, s65
    s_add_u32 m0, s66, 98304
    s_add_u32 s7, s75, 0
    buffer_load_dwordx4 v7, s[24:27], s7 offen lds
    s_add_u32 m0, s66, 99328
    s_add_u32 s7, s75, 8192
    buffer_load_dwordx4 v8, s[24:27], s7 offen lds
    s_add_u32 m0, s66, 100352
    s_add_u32 s7, s75, 16384
    buffer_load_dwordx4 v7, s[24:27], s7 offen lds
    s_add_u32 m0, s66, 101376
    s_add_u32 s7, s75, 24576
    buffer_load_dwordx4 v8, s[24:27], s7 offen lds
    s_add_u32 m0, s67, 114688
    s_add_u32 s7, s74, 0
    buffer_load_dwordx4 v9, s[28:31], s7 offen lds
    s_add_u32 m0, s67, 118784
    s_add_u32 s7, s74, 0
    buffer_load_dwordx4 v10, s[32:35], s7 offen lds
    s_lshl_b32 s7, s6, 2
    s_add_u32 s7, s7, s59
    s_lshl_b32 s7, s7, 15
    s_lshl_b32 s56, s5, 11
    s_add_u32 s7, s7, s56
    s_add_u32 s7, s7, 6291456
    v_mov_b32 v120, -1
    v_mov_b32 v121, -1
    v_mov_b32 v122, -1
    v_mov_b32 v123, -1
    buffer_store_dwordx4 v[120:123], v11, s[16:19], s7 offen sc1
    buffer_store_dwordx4 v[120:123], v11, s[16:19], s7 offen offset:1024 sc1
    s_waitcnt vmcnt(14)
    s_barrier
    s_cmp_lg_u32 s68, 2
    s_cbranch_scc1 Lnosk_4
    ds_read_b128 v[148:151], v30 offset:0
    ds_read_b128 v[152:155], v31 offset:0
    s_waitcnt lgkmcnt(0)
Lnosk_4:
    s_cmp_lg_u32 s68, 3
    s_cbranch_scc1 Lnosk_5
    ds_read_b128 v[148:151], v30 offset:24576
    ds_read_b128 v[152:155], v31 offset:24576
    s_waitcnt lgkmcnt(0)
Lnosk_5:
    ds_read_b128 v[36:39], v24 offset:0
    ds_read_b128 v[44:47], v20 offset:57344
    ds_read_b128 v[48:51], v20 offset:59392
    ds_read_b128 v[40:43], v25 offset:0
    ds_read_b128 v[52:55], v21 offset:57344
    ds_read_b128 v[56:59], v21 offset:59392
    s_waitcnt lgkmcnt(4)
    v_mfma_f32_32x32x16_bf16 v[64:79], v[36:39], v[44:47], v[64:79]
    s_waitcnt lgkmcnt(3)
    v_mfma_f32_32x32x16_bf16 v[80:95], v[36:39], v[48:51], v[80:95]
    ds_read_b128 v[36:39], v26 offset:0
    ds_read_b128 v[44:47], v22 offset:57344
    ds_read_b128 v[48:51], v22 offset:59392
    s_waitcnt lgkmcnt(4)
    v_mfma_f32_32x32x16_bf16 v[64:79], v[40:43], v[52:55], v[64:79]
    s_waitcnt lgkmcnt(3)
    v_mfma_f32_32x32x16_bf16 v[80:95], v[40:43], v[56:59], v[80:95]
    ds_read_b128 v[40:43], v27 offset:0
    ds_read_b128 v[52:55], v23 offset:57344
    ds_read_b128 v[56:59], v23 offset:59392
    s_waitcnt lgkmcnt(4)
    v_mfma_f32_32x32x16_bf16 v[64:79], v[36:39], v[44:47], v[64:79]
    s_waitcnt lgkmcnt(3)
    v_mfma_f32_32x32x16_bf16 v[80:95], v[36:39], v[48:51], v[80:95]
    ds_read_b128 v[36:39], v24 offset:24576
    ds_read_b128 v[44:47], v20 offset:8192
    ds_read_b128 v[48:51], v20 offset:10240
    s_waitcnt lgkmcnt(4)
    v_mfma_f32_32x32x16_bf16 v[64:79], v[40:43], v[52:55], v[64:79]
    s_waitcnt lgkmcnt(3)
    v_mfma_f32_32x32x16_bf16 v[80:95], v[40:43], v[56:59], v[80:95]
    ds_read_b128 v[40:43], v25 offset:24576
    ds_read_b128 v[52:55], v21 offset:8192
    ds_read_b128 v[56:59], v21 offset:10240
    s_waitcnt lgkmcnt(4)
    v_mfma_f32_32x32x16_bf16 v[64:79], v[36:39], v[44:47], v[64:79]
    s_waitcnt lgkmcnt(3)
    v_mfma_f32_32x32x16_bf16 v[80:95], v[36:39], v[48:51], v[80:95]
    ds_read_b128 v[36:39], v26 offset:24576
    ds_read_b128 v[44:47], v22 offset:8192
    ds_read_b128 v[48:51], v22 offset:10240
    s_waitcnt lgkmcnt(4)
    v_mfma_f32_32x32x16_bf16 v[64:79], v[40:43], v[52:55], v[64:79]
    s_waitcnt lgkmcnt(3)
    v_mfma_f32_32x32x16_bf16 v[80:95], v[40:43], v[56:59], v[80:95]
    ds_read_b128 v[40:43], v27 offset:24576
    ds_read_b128 v[52:55], v23 offset:8192
    ds_read_b128 v[56:59], v23 offset:10240
    s_waitcnt lgkmcnt(4)
    v_mfma_f32_32x32x16_bf16 v[64:79], v[36:39], v[44:47], v[64:79]
    s_waitcnt lgkmcnt(3)
    v_mfma_f32_32x32x16_bf16 v[80:95], v[36:39], v[48:51], v[80:95]
    s_waitcnt lgkmcnt(1)
    v_mfma_f32_32x32x16_bf16 v[64:79], v[40:43], v[52:55], v[64:79]
    s_waitcnt lgkmcnt(0)
    v_mfma_f32_32x32x16_bf16 v[80:95], v[40:43], v[56:59], v[80:95]
    s_waitcnt vmcnt(2)
    s_barrier
    s_lshl_b32 s58, s6, 4
    s_add_u32 s58, s58, s5
    s_lshl_b32 s58, s58, 2
    s_add_u32 s58, s58, s59
    s_lshl_b32 s58, s58, 7
    s_add_u32 s58, s58, 13762560
    s_waitcnt vmcnt(0)
    v_mov_b32 v14, s69
    v_mov_b32 v15, 0
    s_mov_b64 exec, 1
    buffer_store_dword v14, v15, s[16:19], s58 offen sc1
    s_mov_b64 exec, -1
    s_add_u32 s56, s70, 6
    s_and_b32 s56, s56, 7
    s_lshl_b32 s56, s56, 7
    s_add_u32 s57, s56, s64
    s_add_u32 s56, s56, s65
    s_add_u32 m0, s66, 122880
    s_add_u32 s7, s57, 0
    buffer_load_dwordx4 v7, s[24:27], s7 offen lds
    s_cmp_lg_u32 s68, 4
    s_cbranch_scc1 Lnosk_6
    ds_read_b128 v[148:151], v28 offset:0
    ds_read_b128 v[152:155], v29 offset:0
    s_waitcnt lgkmcnt(0)
Lnosk_6:
    s_cmp_lg_u32 s68, 5
    s_cbranch_scc1 Lnosk_7
    ds_read_b128 v[148:151], v28 offset:32768
    ds_read_b128 v[152:155], v29 offset:32768
    s_waitcnt lgkmcnt(0)
Lnosk_7:
    ds_read_b128 v[36:39], v16 offset:0
    ds_read_b128 v[44:47], v20 offset:0
    ds_read_b128 v[48:51], v20 offset:2048
    ds_read_b128 v[40:43], v17 offset:0
    ds_read_b128 v[52:55], v21 offset:0
    ds_read_b128 v[56:59], v21 offset:2048
    s_add_u32 m0, s66, 123904
    s_add_u32 s7, s57, 8192
    buffer_load_dwordx4 v8, s[24:27], s7 offen lds
    s_waitcnt lgkmcnt(4)
    v_mfma_f32_32x32x16_bf16 v[64:79], v[36:39], v[44:47], v[64:79]
    s_waitcnt lgkmcnt(3)
    v_mfma_f32_32x32x16_bf16 v[80:95], v[36:39], v[48:51], v[80:95]
    ds_read_b128 v[36:39], v18 offset:0
    ds_read_b128 v[44:47], v22 offset:0
    ds_read_b128 v[48:51], v22 offset:2048
    s_add_u32 m0, s66, 124928
    s_add_u32 s7, s57, 16384
    buffer_load_dwordx4 v7, s[24:27], s7 offen lds
    s_waitcnt lgkmcnt(4)
    v_mfma_f32_32x32x16_bf16 v[64:79], v[40:43], v[52:55], v[64:79]
    s_waitcnt lgkmcnt(3)
    v_mfma_f32_32x32x16_bf16 v[80:95], v[40:43], v[56:59], v[80:95]
    ds_read_b128 v[40:43], v19 offset:0
    ds_read_b128 v[52:55], v23 offset:0
    ds_read_b128 v[56:59], v23 offset:2048
    s_add_u32 m0, s66, 125952
    s_add_u32 s7, s57, 24576
    buffer_load_dwordx4 v8, s[24:27], s7 offen lds
    s_add_u32 m0, s67, 139264
    s_add_u32 s7, s56, 0
    buffer_load_dwordx4 v9, s[28:31], s7 offen lds
    s_waitcnt lgkmcnt(4)
    v_mfma_f32_32x32x16_bf16 v[64:79], v[36:39], v[44:47], v[64:79]
    s_waitcnt lgkmcnt(3)
    v_mfma_f32_32x32x16_bf16 v[80:95], v[36:39], v[48:51], v[80:95]
    ds_read_b128 v[36:39], v16 offset:32768
    ds_read_b128 v[44:47], v20 offset:32768
    ds_read_b128 v[48:51], v20 offset:34816
    s_add_u32 m0, s67, 143360
    s_add_u32 s7, s56, 0
    buffer_load_dwordx4 v10, s[32:35], s7 offen lds
    s_waitcnt lgkmcnt(4)
    v_mfma_f32_32x32x16_bf16 v[64:79], v[40:43], v[52:55], v[64:79]
    s_waitcnt lgkmcnt(3)
    v_mfma_f32_32x32x16_bf16 v[80:95], v[40:43], v[56:59], v[80:95]
    ds_read_b128 v[40:43], v17 offset:32768
    ds_read_b128 v[52:55], v21 offset:32768
    ds_read_b128 v[56:59], v21 offset:34816
    s_add_u32 s74, s70, 7
    s_and_b32 s74, s74, 7
    s_lshl_b32 s74, s74, 7
    s_add_u32 s75, s74, s64
    s_add_u32 s74, s74, s65
    s_add_u32 m0, s66, 147456
    s_add_u32 s7, s75, 0
    buffer_load_dwordx4 v7, s[24:27], s7 offen lds
    s_waitcnt lgkmcnt(4)
    v_mfma_f32_32x32x16_bf16 v[64:79], v[36:39], v[44:47], v[64:79]
    s_waitcnt lgkmcnt(3)
    v_mfma_f32_32x32x16_bf16 v[80:95], v[36:39], v[48:51], v[80:95]
    ds_read_b128 v[36:39], v18 offset:32768
    ds_read_b128 v[44:47], v22 offset:32768
    ds_read_b128 v[48:51], v22 offset:34816
    s_add_u32 m0, s66, 148480
    s_add_u32 s7, s75, 8192
    buffer_load_dwordx4 v8, s[24:27], s7 offen lds
    s_add_u32 m0, s66, 149504
    s_add_u32 s7, s75, 16384
    buffer_load_dwordx4 v7, s[24:27], s7 offen lds
    s_waitcnt lgkmcnt(4)
    v_mfma_f32_32x32x16_bf16 v[64:79], v[40:43], v[52:55], v[64:79]
    s_waitcnt lgkmcnt(3)
    v_mfma_f32_32x32x16_bf16 v[80:95], v[40:43], v[56:59], v[80:95]
    ds_read_b128 v[40:43], v19 offset:32768
    ds_read_b128 v[52:55], v23 offset:32768
    ds_read_b128 v[56:59], v23 offset:34816
    s_add_u32 m0, s66, 150528
    s_add_u32 s7, s75, 24576
    buffer_load_dwordx4 v8, s[24:27], s7 offen lds
    s_waitcnt lgkmcnt(4)
    v_mfma_f32_32x32x16_bf16 v[64:79], v[36:39], v[44:47], v[64:79]
    s_waitcnt lgkmcnt(3)
    v_mfma_f32_32x32x16_bf16 v[80:95], v[36:39], v[48:51], v[80:95]
    s_add_u32 m0, s67, 90112
    s_add_u32 s7, s74, 0
    buffer_load_dwordx4 v9, s[28:31], s7 offen lds
    s_waitcnt lgkmcnt(1)
    v_mfma_f32_32x32x16_bf16 v[64:79], v[40:43], v[52:55], v[64:79]
    s_waitcnt lgkmcnt(0)
    v_mfma_f32_32x32x16_bf16 v[80:95], v[40:43], v[56:59], v[80:95]
    s_add_u32 m0, s67, 94208
    s_add_u32 s7, s74, 0
    buffer_load_dwordx4 v10, s[32:35], s7 offen lds
    s_waitcnt vmcnt(0)
    s_barrier
    s_cmp_lg_u32 s68, 6
    s_cbranch_scc1 Lnosk_8
    ds_read_b128 v[148:151], v30 offset:0
    ds_read_b128 v[152:155], v31 offset:0
    s_waitcnt lgkmcnt(0)
Lnosk_8:
    s_cmp_lg_u32 s68, 7
    s_cbranch_scc1 Lnosk_9
    ds_read_b128 v[148:151], v30 offset:24576
    ds_read_b128 v[152:155], v31 offset:24576
    s_waitcnt lgkmcnt(0)
Lnosk_9:
    ds_read_b128 v[36:39], v24 offset:0
    ds_read_b128 v[44:47], v20 offset:57344
    ds_read_b128 v[48:51], v20 offset:59392
    ds_read_b128 v[40:43], v25 offset:0
    ds_read_b128 v[52:55], v21 offset:57344
    ds_read_b128 v[56:59], v21 offset:59392
    s_waitcnt lgkmcnt(4)
    v_mfma_f32_32x32x16_bf16 v[64:79], v[36:39], v[44:47], v[64:79]
    s_waitcnt lgkmcnt(3)
    v_mfma_f32_32x32x16_bf16 v[80:95], v[36:39], v[48:51], v[80:95]
    ds_read_b128 v[36:39], v26 offset:0
    ds_read_b128 v[44:47], v22 offset:57344
    ds_read_b128 v[48:51], v22 offset:59392
    s_waitcnt lgkmcnt(4)
    v_mfma_f32_32x32x16_bf16 v[64:79], v[40:43], v[52:55], v[64:79]
    s_waitcnt lgkmcnt(3)
    v_mfma_f32_32x32x16_bf16 v[80:95], v[40:43], v[56:59], v[80:95]
    ds_read_b128 v[40:43], v27 offset:0
    ds_read_b128 v[52:55], v23 offset:57344
    ds_read_b128 v[56:59], v23 offset:59392
    s_waitcnt lgkmcnt(4)
    v_mfma_f32_32x32x16_bf16 v[64:79], v[36:39], v[44:47], v[64:79]
    s_waitcnt lgkmcnt(3)
    v_mfma_f32_32x32x16_bf16 v[80:95], v[36:39], v[48:51], v[80:95]
    ds_read_b128 v[36:39], v24 offset:24576
    ds_read_b128 v[44:47], v20 offset:8192
    ds_read_b128 v[48:51], v20 offset:10240
    s_waitcnt lgkmcnt(4)
    v_mfma_f32_32x32x16_bf16 v[64:79], v[40:43], v[52:55], v[64:79]
    s_waitcnt lgkmcnt(3)
    v_mfma_f32_32x32x16_bf16 v[80:95], v[40:43], v[56:59], v[80:95]
    ds_read_b128 v[40:43], v25 offset:24576
    ds_read_b128 v[52:55], v21 offset:8192
    ds_read_b128 v[56:59], v21 offset:10240
    s_waitcnt lgkmcnt(4)
    v_mfma_f32_32x32x16_bf16 v[64:79], v[36:39], v[44:47], v[64:79]
    s_waitcnt lgkmcnt(3)
    v_mfma_f32_32x32x16_bf16 v[80:95], v[36:39], v[48:51], v[80:95]
    ds_read_b128 v[36:39], v26 offset:24576
    ds_read_b128 v[44:47], v22 offset:8192
    ds_read_b128 v[48:51], v22 offset:10240
    s_waitcnt lgkmcnt(4)
    v_mfma_f32_32x32x16_bf16 v[64:79], v[40:43], v[52:55], v[64:79]
    s_waitcnt lgkmcnt(3)
    v_mfma_f32_32x32x16_bf16 v[80:95], v[40:43], v[56:59], v[80:95]
    ds_read_b128 v[40:43], v27 offset:24576
    ds_read_b128 v[52:55], v23 offset:8192
    ds_read_b128 v[56:59], v23 offset:10240
    s_waitcnt lgkmcnt(4)
    v_mfma_f32_32x32x16_bf16 v[64:79], v[36:39], v[44:47], v[64:79]
    s_waitcnt lgkmcnt(3)
    v_mfma_f32_32x32x16_bf16 v[80:95], v[36:39], v[48:51], v[80:95]
    s_waitcnt lgkmcnt(1)
    v_mfma_f32_32x32x16_bf16 v[64:79], v[40:43], v[52:55], v[64:79]
    s_waitcnt lgkmcnt(0)
    v_mfma_f32_32x32x16_bf16 v[80:95], v[40:43], v[56:59], v[80:95]
    s_setprio 3
    s_nop 8
    v_fma_f32 v117, v105, v64, v65
    s_nop 0
    v_fma_f32 v118, v106, v80, v81
    v_fmac_f32_dpp v117, v64, v107 quad_perm:[1,0,3,2] row_mask:0xf bank_mask:0xf
    s_nop 0
    v_fmac_f32_dpp v118, v80, v108 quad_perm:[1,0,3,2] row_mask:0xf bank_mask:0xf
    v_fma_f32 v140, v105, v117, v66
    v_fma_f32 v141, v106, v118, v82
    s_nop 0
    v_fmac_f32_dpp v140, v117, v107 quad_perm:[1,0,3,2] row_mask:0xf bank_mask:0xf
    v_fmac_f32_dpp v141, v118, v108 quad_perm:[1,0,3,2] row_mask:0xf bank_mask:0xf
    v_fma_f32 v117, v105, v140, v67
    v_fma_f32 v118, v106, v141, v83
    s_nop 0
    v_fmac_f32_dpp v117, v140, v107 quad_perm:[1,0,3,2] row_mask:0xf bank_mask:0xf
    v_fmac_f32_dpp v118, v141, v108 quad_perm:[1,0,3,2] row_mask:0xf bank_mask:0xf
    v_fma_f32 v140, v105, v117, v68
    v_fma_f32 v141, v106, v118, v84
    s_nop 0
    v_fmac_f32_dpp v140, v117, v107 quad_perm:[1,0,3,2] row_mask:0xf bank_mask:0xf
    v_fmac_f32_dpp v141, v118, v108 quad_perm:[1,0,3,2] row_mask:0xf bank_mask:0xf
    v_fma_f32 v117, v105, v140, v69
    v_fma_f32 v118, v106, v141, v85
    s_nop 0
    v_fmac_f32_dpp v117, v140, v107 quad_perm:[1,0,3,2] row_mask:0xf bank_mask:0xf
    v_fmac_f32_dpp v118, v141, v108 quad_perm:[1,0,3,2] row_mask:0xf bank_mask:0xf
    v_fma_f32 v140, v105, v117, v70
    v_fma_f32 v141, v106, v118, v86
    s_nop 0
    v_fmac_f32_dpp v140, v117, v107 quad_perm:[1,0,3,2] row_mask:0xf bank_mask:0xf
    v_fmac_f32_dpp v141, v118, v108 quad_perm:[1,0,3,2] row_mask:0xf bank_mask:0xf
    v_fma_f32 v117, v105, v140, v71
    v_fma_f32 v118, v106, v141, v87
    s_nop 0
    v_fmac_f32_dpp v117, v140, v107 quad_perm:[1,0,3,2] row_mask:0xf bank_mask:0xf
    v_fmac_f32_dpp v118, v141, v108 quad_perm:[1,0,3,2] row_mask:0xf bank_mask:0xf
    v_fma_f32 v140, v105, v117, v72
    v_fma_f32 v141, v106, v118, v88
    s_nop 0
    v_fmac_f32_dpp v140, v117, v107 quad_perm:[1,0,3,2] row_mask:0xf bank_mask:0xf
    v_fmac_f32_dpp v141, v118, v108 quad_perm:[1,0,3,2] row_mask:0xf bank_mask:0xf
    v_fma_f32 v117, v105, v140, v73
    v_fma_f32 v118, v106, v141, v89
    s_nop 0
    v_fmac_f32_dpp v117, v140, v107 quad_perm:[1,0,3,2] row_mask:0xf bank_mask:0xf
    v_fmac_f32_dpp v118, v141, v108 quad_perm:[1,0,3,2] row_mask:0xf bank_mask:0xf
    v_fma_f32 v140, v105, v117, v74
    v_fma_f32 v141, v106, v118, v90
    s_nop 0
    v_fmac_f32_dpp v140, v117, v107 quad_perm:[1,0,3,2] row_mask:0xf bank_mask:0xf
    v_fmac_f32_dpp v141, v118, v108 quad_perm:[1,0,3,2] row_mask:0xf bank_mask:0xf
    v_fma_f32 v117, v105, v140, v75
    v_fma_f32 v118, v106, v141, v91
    s_nop 0
    v_fmac_f32_dpp v117, v140, v107 quad_perm:[1,0,3,2] row_mask:0xf bank_mask:0xf
    v_fmac_f32_dpp v118, v141, v108 quad_perm:[1,0,3,2] row_mask:0xf bank_mask:0xf
    v_fma_f32 v140, v105, v117, v76
    v_fma_f32 v141, v106, v118, v92
    s_nop 0
    v_fmac_f32_dpp v140, v117, v107 quad_perm:[1,0,3,2] row_mask:0xf bank_mask:0xf
    v_fmac_f32_dpp v141, v118, v108 quad_perm:[1,0,3,2] row_mask:0xf bank_mask:0xf
    v_fma_f32 v117, v105, v140, v77
    v_fma_f32 v118, v106, v141, v93
    s_nop 0
    v_fmac_f32_dpp v117, v140, v107 quad_perm:[1,0,3,2] row_mask:0xf bank_mask:0xf
    v_fmac_f32_dpp v118, v141, v108 quad_perm:[1,0,3,2] row_mask:0xf bank_mask:0xf
    v_fma_f32 v140, v105, v117, v78
    v_fma_f32 v141, v106, v118, v94
    s_nop 0
    v_fmac_f32_dpp v140, v117, v107 quad_perm:[1,0,3,2] row_mask:0xf bank_mask:0xf
    v_fmac_f32_dpp v141, v118, v108 quad_perm:[1,0,3,2] row_mask:0xf bank_mask:0xf
    v_fma_f32 v117, v105, v140, v79
    v_fma_f32 v118, v106, v141, v95
    s_nop 0
    v_fmac_f32_dpp v117, v140, v107 quad_perm:[1,0,3,2] row_mask:0xf bank_mask:0xf
    v_fmac_f32_dpp v118, v141, v108 quad_perm:[1,0,3,2] row_mask:0xf bank_mask:0xf
    s_lshl_b32 s7, s59, 9
    s_add_u32 s7, s7, 65536
    v_lshrrev_b32 v99, 5, v1
    v_lshlrev_b32 v99, 8, v99
    v_and_b32 v100, 31, v1
    v_lshl_add_u32 v99, v100, 2, v99
    v_add_u32 v99, s7, v99
    ds_write_b32 v99, v117
    ds_write_b32 v99, v118 offset:128
    s_waitcnt lgkmcnt(0)
    s_barrier
    v_and_b32 v99, 31, v1
    v_lshlrev_b32 v99, 2, v99
    v_add_u32 v99, 65536, v99
    ds_read_b32 v120, v99 offset:0
    ds_read_b32 v128, v99 offset:128
    ds_read_b32 v121, v99 offset:256
    ds_read_b32 v129, v99 offset:384
    ds_read_b32 v122, v99 offset:512
    ds_read_b32 v130, v99 offset:640
    ds_read_b32 v123, v99 offset:768
    ds_read_b32 v131, v99 offset:896
    ds_read_b32 v124, v99 offset:1024
    ds_read_b32 v132, v99 offset:1152
    ds_read_b32 v125, v99 offset:1280
    ds_read_b32 v133, v99 offset:1408
    ds_read_b32 v126, v99 offset:1536
    ds_read_b32 v134, v99 offset:1664
    ds_read_b32 v127, v99 offset:1792
    ds_read_b32 v135, v99 offset:1920
    s_cmp_lg_u32 s59, 0
    s_cbranch_scc1 LnoE_10
    s_waitcnt lgkmcnt(13)
    v_fma_f32 v117, v109, v120, v121
    s_waitcnt lgkmcnt(12)
    v_fma_f32 v118, v110, v128, v129
    v_fmac_f32_dpp v117, v120, v111 quad_perm:[1,0,3,2] row_mask:0xf bank_mask:0xf
    s_nop 0
    v_fmac_f32_dpp v118, v128, v112 quad_perm:[1,0,3,2] row_mask:0xf bank_mask:0xf
    s_waitcnt lgkmcnt(11)
    v_fma_f32 v140, v109, v117, v122
    s_waitcnt lgkmcnt(10)
    v_fma_f32 v141, v110, v118, v130
    v_fmac_f32_dpp v140, v117, v111 quad_perm:[1,0,3,2] row_mask:0xf bank_mask:0xf
    s_nop 0
    v_fmac_f32_dpp v141, v118, v112 quad_perm:[1,0,3,2] row_mask:0xf bank_mask:0xf
    s_waitcnt lgkmcnt(9)
    v_fma_f32 v117, v109, v140, v123
    s_waitcnt lgkmcnt(8)
    v_fma_f32 v118, v110, v141, v131
    v_fmac_f32_dpp v117, v140, v111 quad_perm:[1,0,3,2] row_mask:0xf bank_mask:0xf
    s_nop 0
    v_fmac_f32_dpp v118, v141, v112 quad_perm:[1,0,3,2] row_mask:0xf bank_mask:0xf
    s_waitcnt lgkmcnt(7)
    v_fma_f32 v140, v109, v117, v124
    s_waitcnt lgkmcnt(6)
    v_fma_f32 v141, v110, v118, v132
    v_fmac_f32_dpp v140, v117, v111 quad_perm:[1,0,3,2] row_mask:0xf bank_mask:0xf
    s_nop 0
    v_fmac_f32_dpp v141, v118, v112 quad_perm:[1,0,3,2] row_mask:0xf bank_mask:0xf
    s_waitcnt lgkmcnt(5)
    v_fma_f32 v117, v109, v140, v125
    s_waitcnt lgkmcnt(4)
    v_fma_f32 v118, v110, v141, v133
    v_fmac_f32_dpp v117, v140, v111 quad_perm:[1,0,3,2] row_mask:0xf bank_mask:0xf
    s_nop 0
    v_fmac_f32_dpp v118, v141, v112 quad_perm:[1,0,3,2] row_mask:0xf bank_mask:0xf
    s_waitcnt lgkmcnt(3)
    v_fma_f32 v140, v109, v117, v126
    s_waitcnt lgkmcnt(2)
    v_fma_f32 v141, v110, v118, v134
    v_fmac_f32_dpp v140, v117, v111 quad_perm:[1,0,3,2] row_mask:0xf bank_mask:0xf
    s_nop 0
    v_fmac_f32_dpp v141, v118, v112 quad_perm:[1,0,3,2] row_mask:0xf bank_mask:0xf
    s_waitcnt lgkmcnt(1)
    v_fma_f32 v117, v109, v140, v127
    s_waitcnt lgkmcnt(0)
    v_fma_f32 v118, v110, v141, v135
    v_fmac_f32_dpp v117, v140, v111 quad_perm:[1,0,3,2] row_mask:0xf bank_mask:0xf
    s_nop 0
    v_fmac_f32_dpp v118, v141, v112 quad_perm:[1,0,3,2] row_mask:0xf bank_mask:0xf
    v_lshrrev_b32 v99, 5, v1
    v_cmp_eq_u32 vcc, 1, v99
    s_nop 1
    v_cndmask_b32 v144, v117, v118, vcc
    v_mov_b32 v145, s69
    v_lshlrev_b32 v99, 3, v1
    s_lshl_b32 s7, s6, 4
    s_add_u32 s7, s7, s5
    s_lshl_b32 s7, s7, 9
    s_add_u32 s7, s7, 12582912
    buffer_store_dwordx2 v[144:145], v99, s[16:19], s7 offen sc1
LnoE_10:
    s_waitcnt lgkmcnt(0)
    s_lshl_b32 s58, s59, 1
    s_cmp_le_u32 s58, 0
    s_cselect_b32 s74, 0, -1
    s_cmp_lt_u32 s58, 0
    s_cselect_b32 s75, 0, -1
    v_cndmask_b32 v136, 0, v120, s[74:75]
    v_cndmask_b32 v137, 0, v128, s[74:75]
    s_cmp_le_u32 s58, 1
    s_cselect_b32 s74, 0, -1
    s_cmp_lt_u32 s58, 1
    s_cselect_b32 s75, 0, -1
    v_fma_f32 v142, v109, v120, v121
    v_fma_f32 v143, v110, v128, v129
    s_nop 0
    v_fmac_f32_dpp v142, v120, v111 quad_perm:[1,0,3,2] row_mask:0xf bank_mask:0xf
    v_fmac_f32_dpp v143, v128, v112 quad_perm:[1,0,3,2] row_mask:0xf bank_mask:0xf
    v_cndmask_b32 v136, v136, v142, s[74:75]
    v_cndmask_b32 v137, v137, v143, s[74:75]
    s_cmp_le_u32 s58, 2
    s_cselect_b32 s74, 0, -1
    s_cmp_lt_u32 s58, 2
    s_cselect_b32 s75, 0, -1
    v_fma_f32 v140, v109, v142, v122
    v_fma_f32 v141, v110, v143, v130
    s_nop 0
    v_fmac_f32_dpp v140, v142, v111 quad_perm:[1,0,3,2] row_mask:0xf bank_mask:0xf
    v_fmac_f32_dpp v141, v143, v112 quad_perm:[1,0,3,2] row_mask:0xf bank_mask:0xf
    v_cndmask_b32 v136, v136, v140, s[74:75]
    v_cndmask_b32 v137, v137, v141, s[74:75]
    s_cmp_le_u32 s58, 3
    s_cselect_b32 s74, 0, -1
    s_cmp_lt_u32 s58, 3
    s_cselect_b32 s75, 0, -1
    v_fma_f32 v142, v109, v140, v123
    v_fma_f32 v143, v110, v141, v131
    s_nop 0
    v_fmac_f32_dpp v142, v140, v111 quad_perm:[1,0,3,2] row_mask:0xf bank_mask:0xf
    v_fmac_f32_dpp v143, v141, v112 quad_perm:[1,0,3,2] row_mask:0xf bank_mask:0xf
    v_cndmask_b32 v136, v136, v142, s[74:75]
    v_cndmask_b32 v137, v137, v143, s[74:75]
    s_cmp_le_u32 s58, 4
    s_cselect_b32 s74, 0, -1
    s_cmp_lt_u32 s58, 4
    s_cselect_b32 s75, 0, -1
    v_fma_f32 v140, v109, v142, v124
    v_fma_f32 v141, v110, v143, v132
    s_nop 0
    v_fmac_f32_dpp v140, v142, v111 quad_perm:[1,0,3,2] row_mask:0xf bank_mask:0xf
    v_fmac_f32_dpp v141, v143, v112 quad_perm:[1,0,3,2] row_mask:0xf bank_mask:0xf
    v_cndmask_b32 v136, v136, v140, s[74:75]
    v_cndmask_b32 v137, v137, v141, s[74:75]
    s_cmp_le_u32 s58, 5
    s_cselect_b32 s74, 0, -1
    s_cmp_lt_u32 s58, 5
    s_cselect_b32 s75, 0, -1
    v_fma_f32 v142, v109, v140, v125
    v_fma_f32 v143, v110, v141, v133
    s_nop 0
    v_fmac_f32_dpp v142, v140, v111 quad_perm:[1,0,3,2] row_mask:0xf bank_mask:0xf
    v_fmac_f32_dpp v143, v141, v112 quad_perm:[1,0,3,2] row_mask:0xf bank_mask:0xf
    v_cndmask_b32 v136, v136, v142, s[74:75]
    v_cndmask_b32 v137, v137, v143, s[74:75]
    s_cmp_le_u32 s58, 6
    s_cselect_b32 s74, 0, -1
    s_cmp_lt_u32 s58, 6
    s_cselect_b32 s75, 0, -1
    v_fma_f32 v140, v109, v142, v126
    v_fma_f32 v141, v110, v143, v134
    s_nop 0
    v_fmac_f32_dpp v140, v142, v111 quad_perm:[1,0,3,2] row_mask:0xf bank_mask:0xf
    v_fmac_f32_dpp v141, v143, v112 quad_perm:[1,0,3,2] row_mask:0xf bank_mask:0xf
    v_cndmask_b32 v136, v136, v140, s[74:75]
    v_cndmask_b32 v137, v137, v141, s[74:75]
    s_lshl_b32 s56, s5, 18
    s_lshr_b32 s7, s59, 1
    s_lshl_b32 s7, s7, 17
    s_add_u32 s56, s56, s7
    s_lshl_b32 s7, s6, 13
    s_add_u32 s56, s56, s7
    s_and_b32 s7, s59, 1
    s_lshl_b32 s7, s7, 11
    s_add_u32 s56, s56, s7
    s_add_u32 s56, s56, 8388608
    v_and_b32 v15, 15, v1
    v_lshlrev_b32 v15, 7, v15
    v_bfe_u32 v14, v1, 4, 1
    v_lshl_add_u32 v15, v14, 12, v15
    buffer_load_dword v163, v15, s[16:19], s56 offen
    s_setprio 1
    s_barrier
    s_lshl_b32 s60, s5, 18
    s_and_b32 s7, s6, 1
    s_lshl_b32 s7, s7, 17
    s_add_u32 s60, s60, s7
    s_lshl_b32 s7, s59, 12
    s_add_u32 s60, s60, s7
    s_add_u32 s60, s60, 8388608
    s_add_u32 s61, s7, 65536
    s_lshr_b32 s62, s6, 1
    s_lshl_b32 s62, s62, 16
    s_lshl_b32 s7, s59, 14
    s_add_u32 s62, s62, s7
    s_lshl_b32 s63, s59, 11
    s_add_u32 s63, s63, 81920
    s_barrier
    v_lshlrev_b32 v119, 3, v1
    s_lshl_b32 s56, s6, 13
    s_lshl_b32 s57, s59, 11
    s_add_u32 s56, s56, s57
    s_add_u32 s56, s56, 12582912
    s_add_u32 m0, s57, 131072
    s_add_u32 s7, s56, 0
    buffer_load_dwordx4 v11, s[16:19], s7 offen sc1 lds
    s_add_u32 m0, s57, 132096
    s_add_u32 s7, s56, 1024
    buffer_load_dwordx4 v11, s[16:19], s7 offen sc1 lds
    s_lshr_b32 s7, s6, 1
    s_lshl_b32 s7, s7, 6
    s_lshr_b32 s56, s59, 1
    s_lshl_b32 s56, s56, 5
    s_add_u32 s7, s7, s56
    v_and_b32 v2, 31, v1
    v_add_u32 v2, s7, v2
    v_lshlrev_b32 v2, 1, v2
    global_load_ushort v156, v2, s[54:55]
    s_add_u32 s56, s70, 0
    s_and_b32 s56, s56, 7
    s_lshl_b32 s57, s56, 14
    s_add_u32 s57, s57, s60
    s_lshl_b32 s56, s56, 7
    s_add_u32 s56, s56, s62
    s_add_u32 m0, s63, 0
    s_add_u32 s7, s56, 0
    buffer_load_dwordx4 v7, s[36:39], s7 offen lds
    s_add_u32 m0, s63, 1024
    s_add_u32 s7, s56, 8192
    buffer_load_dwordx4 v8, s[36:39], s7 offen lds
    s_add_u32 m0, s63, 8192
    s_add_u32 s7, s56, 0
    buffer_load_dwordx4 v7, s[40:43], s7 offen lds
    s_add_u32 m0, s63, 9216
    s_add_u32 s7, s56, 8192
    buffer_load_dwordx4 v8, s[40:43], s7 offen lds
    s_waitcnt vmcnt(5)
    s_barrier
    s_setprio 3
    s_mov_b32 s71, 40000
    v_add_u32 v143, 131072, v119
    ds_read_b64 v[34:35], v143 offset:0
    ds_read_b64 v[36:37], v143 offset:512
    ds_read_b64 v[38:39], v143 offset:1024
    ds_read_b64 v[40:41], v143 offset:1536
    ds_read_b64 v[42:43], v143 offset:2048
    ds_read_b64 v[44:45], v143 offset:2560
    ds_read_b64 v[46:47], v143 offset:3072
    ds_read_b64 v[48:49], v143 offset:3584
    ds_read_b64 v[50:51], v143 offset:4096
    ds_read_b64 v[52:53], v143 offset:4608
    ds_read_b64 v[54:55], v143 offset:5120
    ds_read_b64 v[56:57], v143 offset:5632
    ds_read_b64 v[58:59], v143 offset:6144
    ds_read_b64 v[60:61], v143 offset:6656
    ds_read_b64 v[62:63], v143 offset:7168
    s_waitcnt lgkmcnt(0)
Le_retry_12:
    v_mov_b32 v138, 0
    v_mov_b32 v141, 0
    s_cmp_le_u32 s5, 0
    s_cbranch_scc1 Le_done_13
    v_fma_f32 v140, v103, v138, v34
    v_xor_b32 v142, s69, v35
    v_or_b32 v141, v141, v142
    v_fmac_f32_dpp v140, v138, v104 quad_perm:[1,0,3,2] row_mask:0xf bank_mask:0xf
    v_mov_b32 v138, v140
    s_cmp_le_u32 s5, 1
    s_cbranch_scc1 Le_done_13
    v_fma_f32 v140, v103, v138, v36
    v_xor_b32 v142, s69, v37
    v_or_b32 v141, v141, v142
    v_fmac_f32_dpp v140, v138, v104 quad_perm:[1,0,3,2] row_mask:0xf bank_mask:0xf
    v_mov_b32 v138, v140
    s_cmp_le_u32 s5, 2
    s_cbranch_scc1 Le_done_13
    v_fma_f32 v140, v103, v138, v38
    v_xor_b32 v142, s69, v39
    v_or_b32 v141, v141, v142
    v_fmac_f32_dpp v140, v138, v104 quad_perm:[1,0,3,2] row_mask:0xf bank_mask:0xf
    v_mov_b32 v138, v140
    s_cmp_le_u32 s5, 3
    s_cbranch_scc1 Le_done_13
    v_fma_f32 v140, v103, v138, v40
    v_xor_b32 v142, s69, v41
    v_or_b32 v141, v141, v142
    v_fmac_f32_dpp v140, v138, v104 quad_perm:[1,0,3,2] row_mask:0xf bank_mask:0xf
    v_mov_b32 v138, v140
    s_cmp_le_u32 s5, 4
    s_cbranch_scc1 Le_done_13
    v_fma_f32 v140, v103, v138, v42
    v_xor_b32 v142, s69, v43
    v_or_b32 v141, v141, v142
    v_fmac_f32_dpp v140, v138, v104 quad_perm:[1,0,3,2] row_mask:0xf bank_mask:0xf
    v_mov_b32 v138, v140
    s_cmp_le_u32 s5, 5
    s_cbranch_scc1 Le_done_13
    v_fma_f32 v140, v103, v138, v44
    v_xor_b32 v142, s69, v45
    v_or_b32 v141, v141, v142
    v_fmac_f32_dpp v140, v138, v104 quad_perm:[1,0,3,2] row_mask:0xf bank_mask:0xf
    v_mov_b32 v138, v140
    s_cmp_le_u32 s5, 6
    s_cbranch_scc1 Le_done_13
    v_fma_f32 v140, v103, v138, v46
    v_xor_b32 v142, s69, v47
    v_or_b32 v141, v141, v142
    v_fmac_f32_dpp v140, v138, v104 quad_perm:[1,0,3,2] row_mask:0xf bank_mask:0xf
    v_mov_b32 v138, v140
    s_cmp_le_u32 s5, 7
    s_cbranch_scc1 Le_done_13
    v_fma_f32 v140, v103, v138, v48
    v_xor_b32 v142, s69, v49
    v_or_b32 v141, v141, v142
    v_fmac_f32_dpp v140, v138, v104 quad_perm:[1,0,3,2] row_mask:0xf bank_mask:0xf
    v_mov_b32 v138, v140
    s_cmp_le_u32 s5, 8
    s_cbranch_scc1 Le_done_13
    v_fma_f32 v140, v103, v138, v50
    v_xor_b32 v142, s69, v51
    v_or_b32 v141, v141, v142
    v_fmac_f32_dpp v140, v138, v104 quad_perm:[1,0,3,2] row_mask:0xf bank_mask:0xf
    v_mov_b32 v138, v140
    s_cmp_le_u32 s5, 9
    s_cbranch_scc1 Le_done_13
    v_fma_f32 v140, v103, v138, v52
    v_xor_b32 v142, s69, v53
    v_or_b32 v141, v141, v142
    v_fmac_f32_dpp v140, v138, v104 quad_perm:[1,0,3,2] row_mask:0xf bank_mask:0xf
    v_mov_b32 v138, v140
    s_cmp_le_u32 s5, 10
    s_cbranch_scc1 Le_done_13
    v_fma_f32 v140, v103, v138, v54
    v_xor_b32 v142, s69, v55
    v_or_b32 v141, v141, v142
    v_fmac_f32_dpp v140, v138, v104 quad_perm:[1,0,3,2] row_mask:0xf bank_mask:0xf
    v_mov_b32 v138, v140
    s_cmp_le_u32 s5, 11
    s_cbranch_scc1 Le_done_13
    v_fma_f32 v140, v103, v138, v56
    v_xor_b32 v142, s69, v57
    v_or_b32 v141, v141, v142
    v_fmac_f32_dpp v140, v138, v104 quad_perm:[1,0,3,2] row_mask:0xf bank_mask:0xf
    v_mov_b32 v138, v140
    s_cmp_le_u32 s5, 12
    s_cbranch_scc1 Le_done_13
    v_fma_f32 v140, v103, v138, v58
    v_xor_b32 v142, s69, v59
    v_or_b32 v141, v141, v142
    v_fmac_f32_dpp v140, v138, v104 quad_perm:[1,0,3,2] row_mask:0xf bank_mask:0xf
    v_mov_b32 v138, v140
    s_cmp_le_u32 s5, 13
    s_cbranch_scc1 Le_done_13
    v_fma_f32 v140, v103, v138, v60
    v_xor_b32 v142, s69, v61
    v_or_b32 v141, v141, v142
    v_fmac_f32_dpp v140, v138, v104 quad_perm:[1,0,3,2] row_mask:0xf bank_mask:0xf
    v_mov_b32 v138, v140
    s_cmp_le_u32 s5, 14
    s_cbranch_scc1 Le_done_13
    v_fma_f32 v140, v103, v138, v62
    v_xor_b32 v142, s69, v63
    v_or_b32 v141, v141, v142
    v_fmac_f32_dpp v140, v138, v104 quad_perm:[1,0,3,2] row_mask:0xf bank_mask:0xf
    v_mov_b32 v138, v140
Le_done_13:
    v_cmp_ne_u32 vcc, 0, v141
    s_nop 3
    s_cbranch_vccz Le_ok_14
    s_sub_u32 s71, s71, 1
    s_cmp_eq_u32 s71, 0
    s_cbranch_scc1 Le_ok_14
    s_sleep 2
    s_lshl_b32 s7, s6, 13
    s_add_u32 s7, s7, 12582912
    s_cmp_le_u32 s5, 0
    s_cbranch_scc1 Le_ld_15
    buffer_load_dwordx2 v[34:35], v119, s[16:19], s7 offen offset:0 sc1
    s_cmp_le_u32 s5, 1
    s_cbranch_scc1 Le_ld_15
    buffer_load_dwordx2 v[36:37], v119, s[16:19], s7 offen offset:512 sc1
    s_cmp_le_u32 s5, 2
    s_cbranch_scc1 Le_ld_15
    buffer_load_dwordx2 v[38:39], v119, s[16:19], s7 offen offset:1024 sc1
    s_cmp_le_u32 s5, 3
    s_cbranch_scc1 Le_ld_15
    buffer_load_dwordx2 v[40:41], v119, s[16:19], s7 offen offset:1536 sc1
    s_cmp_le_u32 s5, 4
    s_cbranch_scc1 Le_ld_15
    buffer_load_dwordx2 v[42:43], v119, s[16:19], s7 offen offset:2048 sc1
    s_cmp_le_u32 s5, 5
    s_cbranch_scc1 Le_ld_15
    buffer_load_dwordx2 v[44:45], v119, s[16:19], s7 offen offset:2560 sc1
    s_cmp_le_u32 s5, 6
    s_cbranch_scc1 Le_ld_15
    buffer_load_dwordx2 v[46:47], v119, s[16:19], s7 offen offset:3072 sc1
    s_cmp_le_u32 s5, 7
    s_cbranch_scc1 Le_ld_15
    buffer_load_dwordx2 v[48:49], v119, s[16:19], s7 offen offset:3584 sc1
    s_add_u32 s7, s7, 4096
    s_cmp_le_u32 s5, 8
    s_cbranch_scc1 Le_ld_15
    buffer_load_dwordx2 v[50:51], v119, s[16:19], s7 offen offset:0 sc1
    s_cmp_le_u32 s5, 9
    s_cbranch_scc1 Le_ld_15
    buffer_load_dwordx2 v[52:53], v119, s[16:19], s7 offen offset:512 sc1
    s_cmp_le_u32 s5, 10
    s_cbranch_scc1 Le_ld_15
    buffer_load_dwordx2 v[54:55], v119, s[16:19], s7 offen offset:1024 sc1
    s_cmp_le_u32 s5, 11
    s_cbranch_scc1 Le_ld_15
    buffer_load_dwordx2 v[56:57], v119, s[16:19], s7 offen offset:1536 sc1
    s_cmp_le_u32 s5, 12
    s_cbranch_scc1 Le_ld_15
    buffer_load_dwordx2 v[58:59], v119, s[16:19], s7 offen offset:2048 sc1
    s_cmp_le_u32 s5, 13
    s_cbranch_scc1 Le_ld_15
    buffer_load_dwordx2 v[60:61], v119, s[16:19], s7 offen offset:2560 sc1
    s_cmp_le_u32 s5, 14
    s_cbranch_scc1 Le_ld_15
    buffer_load_dwordx2 v[62:63], v119, s[16:19], s7 offen offset:3072 sc1
Le_ld_15:
    s_waitcnt vmcnt(0)
    s_branch Le_retry_12
Le_ok_14:
    s_nop 1
    v_mov_b32 v139, v138
    s_nop 1
    v_permlane32_swap_b32 v138, v139
    v_fma_f32 v142, v158, v138, v136
    v_fma_f32 v143, v159, v139, v137
    s_nop 0
    v_fmac_f32_dpp v142, v138, v160 quad_perm:[1,0,3,2] row_mask:0xf bank_mask:0xf
    v_fmac_f32_dpp v143, v139, v161 quad_perm:[1,0,3,2] row_mask:0xf bank_mask:0xf
    v_fma_f32 v64, v105, v142, v64
    v_fma_f32 v80, v106, v143, v80
    s_nop 0
    v_fmac_f32_dpp v64, v142, v107 quad_perm:[1,0,3,2] row_mask:0xf bank_mask:0xf
    v_fmac_f32_dpp v80, v143, v108 quad_perm:[1,0,3,2] row_mask:0xf bank_mask:0xf
    v_fma_f32 v65, v105, v64, v65
    v_fma_f32 v81, v106, v80, v81
    s_nop 0
    v_fmac_f32_dpp v65, v64, v107 quad_perm:[1,0,3,2] row_mask:0xf bank_mask:0xf
    v_fmac_f32_dpp v81, v80, v108 quad_perm:[1,0,3,2] row_mask:0xf bank_mask:0xf
    v_fma_f32 v66, v105, v65, v66
    v_fma_f32 v82, v106, v81, v82
    s_nop 0
    v_fmac_f32_dpp v66, v65, v107 quad_perm:[1,0,3,2] row_mask:0xf bank_mask:0xf
    v_fmac_f32_dpp v82, v81, v108 quad_perm:[1,0,3,2] row_mask:0xf bank_mask:0xf
    v_fma_f32 v67, v105, v66, v67
    v_fma_f32 v83, v106, v82, v83
    s_nop 0
    v_fmac_f32_dpp v67, v66, v107 quad_perm:[1,0,3,2] row_mask:0xf bank_mask:0xf
    v_fmac_f32_dpp v83, v82, v108 quad_perm:[1,0,3,2] row_mask:0xf bank_mask:0xf
    v_fma_f32 v68, v105, v67, v68
    v_fma_f32 v84, v106, v83, v84
    s_nop 0
    v_fmac_f32_dpp v68, v67, v107 quad_perm:[1,0,3,2] row_mask:0xf bank_mask:0xf
    v_fmac_f32_dpp v84, v83, v108 quad_perm:[1,0,3,2] row_mask:0xf bank_mask:0xf
    v_fma_f32 v69, v105, v68, v69
    v_fma_f32 v85, v106, v84, v85
    s_nop 0
    v_fmac_f32_dpp v69, v68, v107 quad_perm:[1,0,3,2] row_mask:0xf bank_mask:0xf
    v_fmac_f32_dpp v85, v84, v108 quad_perm:[1,0,3,2] row_mask:0xf bank_mask:0xf
    v_fma_f32 v70, v105, v69, v70
    v_fma_f32 v86, v106, v85, v86
    s_nop 0
    v_fmac_f32_dpp v70, v69, v107 quad_perm:[1,0,3,2] row_mask:0xf bank_mask:0xf
    v_fmac_f32_dpp v86, v85, v108 quad_perm:[1,0,3,2] row_mask:0xf bank_mask:0xf
    v_fma_f32 v71, v105, v70, v71
    v_fma_f32 v87, v106, v86, v87
    s_nop 0
    v_fmac_f32_dpp v71, v70, v107 quad_perm:[1,0,3,2] row_mask:0xf bank_mask:0xf
    v_fmac_f32_dpp v87, v86, v108 quad_perm:[1,0,3,2] row_mask:0xf bank_mask:0xf
    v_fma_f32 v72, v105, v71, v72
    v_fma_f32 v88, v106, v87, v88
    s_nop 0
    v_fmac_f32_dpp v72, v71, v107 quad_perm:[1,0,3,2] row_mask:0xf bank_mask:0xf
    v_fmac_f32_dpp v88, v87, v108 quad_perm:[1,0,3,2] row_mask:0xf bank_mask:0xf
    v_fma_f32 v73, v105, v72, v73
    v_fma_f32 v89, v106, v88, v89
    s_nop 0
    v_fmac_f32_dpp v73, v72, v107 quad_perm:[1,0,3,2] row_mask:0xf bank_mask:0xf
    v_fmac_f32_dpp v89, v88, v108 quad_perm:[1,0,3,2] row_mask:0xf bank_mask:0xf
    v_fma_f32 v74, v105, v73, v74
    v_fma_f32 v90, v106, v89, v90
    s_nop 0
    v_fmac_f32_dpp v74, v73, v107 quad_perm:[1,0,3,2] row_mask:0xf bank_mask:0xf
    v_fmac_f32_dpp v90, v89, v108 quad_perm:[1,0,3,2] row_mask:0xf bank_mask:0xf
    v_fma_f32 v75, v105, v74, v75
    v_fma_f32 v91, v106, v90, v91
    s_nop 0
    v_fmac_f32_dpp v75, v74, v107 quad_perm:[1,0,3,2] row_mask:0xf bank_mask:0xf
    v_fmac_f32_dpp v91, v90, v108 quad_perm:[1,0,3,2] row_mask:0xf bank_mask:0xf
    v_fma_f32 v76, v105, v75, v76
    v_fma_f32 v92, v106, v91, v92
    s_nop 0
    v_fmac_f32_dpp v76, v75, v107 quad_perm:[1,0,3,2] row_mask:0xf bank_mask:0xf
    v_fmac_f32_dpp v92, v91, v108 quad_perm:[1,0,3,2] row_mask:0xf bank_mask:0xf
    v_fma_f32 v77, v105, v76, v77
    v_fma_f32 v93, v106, v92, v93
    s_nop 0
    v_fmac_f32_dpp v77, v76, v107 quad_perm:[1,0,3,2] row_mask:0xf bank_mask:0xf
    v_fmac_f32_dpp v93, v92, v108 quad_perm:[1,0,3,2] row_mask:0xf bank_mask:0xf
    v_fma_f32 v78, v105, v77, v78
    v_fma_f32 v94, v106, v93, v94
    s_nop 0
    v_fmac_f32_dpp v78, v77, v107 quad_perm:[1,0,3,2] row_mask:0xf bank_mask:0xf
    v_fmac_f32_dpp v94, v93, v108 quad_perm:[1,0,3,2] row_mask:0xf bank_mask:0xf
    v_fma_f32 v79, v105, v78, v79
    v_fma_f32 v95, v106, v94, v95
    s_nop 0
    v_fmac_f32_dpp v79, v78, v107 quad_perm:[1,0,3,2] row_mask:0xf bank_mask:0xf
    v_fmac_f32_dpp v95, v94, v108 quad_perm:[1,0,3,2] row_mask:0xf bank_mask:0xf
    s_barrier
    v_and_b32 v99, 1, v1
    v_lshlrev_b32 v99, 5, v99
    v_bfe_u32 v100, v1, 1, 4
    v_lshl_add_u32 v99, v100, 1, v99
    v_lshrrev_b32 v100, 5, v1
    v_add_u32 v99, v99, v100
    v_xor_b32 v101, 8, v99
    v_lshlrev_b32 v99, 4, v99
    v_lshlrev_b32 v101, 4, v101
    s_lshl_b32 s56, s5, 18
    s_lshr_b32 s57, s59, 1
    s_lshl_b32 s57, s57, 17
    s_add_u32 s56, s56, s57
    s_lshl_b32 s57, s6, 13
    s_add_u32 s56, s56, s57
    s_and_b32 s57, s59, 1
    s_lshl_b32 s57, s57, 11
    s_add_u32 s56, s56, s57
    s_add_u32 s56, s56, 8388608
    v_mul_f32 v140, v113, v64
    v_mul_f32 v141, v113, v65
    v_mul_f32 v142, v113, v66
    v_mul_f32 v143, v113, v67
    v_fmac_f32_dpp v140, v64, v115 quad_perm:[1,0,3,2] row_mask:0xf bank_mask:0xf
    v_fmac_f32_dpp v141, v65, v115 quad_perm:[1,0,3,2] row_mask:0xf bank_mask:0xf
    v_fmac_f32_dpp v142, v66, v115 quad_perm:[1,0,3,2] row_mask:0xf bank_mask:0xf
    v_fmac_f32_dpp v143, v67, v115 quad_perm:[1,0,3,2] row_mask:0xf bank_mask:0xf
    v_cvt_pk_bf16_f32 v120, v140, v141
    v_cvt_pk_bf16_f32 v121, v142, v143
    v_mul_f32 v140, v113, v68
    v_mul_f32 v141, v113, v69
    v_mul_f32 v142, v113, v70
    v_mul_f32 v143, v113, v71
    v_fmac_f32_dpp v140, v68, v115 quad_perm:[1,0,3,2] row_mask:0xf bank_mask:0xf
    v_fmac_f32_dpp v141, v69, v115 quad_perm:[1,0,3,2] row_mask:0xf bank_mask:0xf
    v_fmac_f32_dpp v142, v70, v115 quad_perm:[1,0,3,2] row_mask:0xf bank_mask:0xf
    v_fmac_f32_dpp v143, v71, v115 quad_perm:[1,0,3,2] row_mask:0xf bank_mask:0xf
    v_cvt_pk_bf16_f32 v122, v140, v141
    v_cvt_pk_bf16_f32 v123, v142, v143
    v_mul_f32 v140, v113, v72
    v_mul_f32 v141, v113, v73
    v_mul_f32 v142, v113, v74
    v_mul_f32 v143, v113, v75
    v_fmac_f32_dpp v140, v72, v115 quad_perm:[1,0,3,2] row_mask:0xf bank_mask:0xf
    v_fmac_f32_dpp v141, v73, v115 quad_perm:[1,0,3,2] row_mask:0xf bank_mask:0xf
    v_fmac_f32_dpp v142, v74, v115 quad_perm:[1,0,3,2] row_mask:0xf bank_mask:0xf
    v_fmac_f32_dpp v143, v75, v115 quad_perm:[1,0,3,2] row_mask:0xf bank_mask:0xf
    v_cvt_pk_bf16_f32 v124, v140, v141
    v_cvt_pk_bf16_f32 v125, v142, v143
    v_mul_f32 v140, v113, v76
    v_mul_f32 v141, v113, v77
    v_mul_f32 v142, v113, v78
    v_mul_f32 v143, v113, v79
    v_fmac_f32_dpp v140, v76, v115 quad_perm:[1,0,3,2] row_mask:0xf bank_mask:0xf
    v_fmac_f32_dpp v141, v77, v115 quad_perm:[1,0,3,2] row_mask:0xf bank_mask:0xf
    v_fmac_f32_dpp v142, v78, v115 quad_perm:[1,0,3,2] row_mask:0xf bank_mask:0xf
    v_fmac_f32_dpp v143, v79, v115 quad_perm:[1,0,3,2] row_mask:0xf bank_mask:0xf
    v_cvt_pk_bf16_f32 v126, v140, v141
    v_cvt_pk_bf16_f32 v127, v142, v143
    v_mul_f32 v140, v114, v80
    v_mul_f32 v141, v114, v81
    v_mul_f32 v142, v114, v82
    v_mul_f32 v143, v114, v83
    v_fmac_f32_dpp v140, v80, v116 quad_perm:[1,0,3,2] row_mask:0xf bank_mask:0xf
    v_fmac_f32_dpp v141, v81, v116 quad_perm:[1,0,3,2] row_mask:0xf bank_mask:0xf
    v_fmac_f32_dpp v142, v82, v116 quad_perm:[1,0,3,2] row_mask:0xf bank_mask:0xf
    v_fmac_f32_dpp v143, v83, v116 quad_perm:[1,0,3,2] row_mask:0xf bank_mask:0xf
    v_cvt_pk_bf16_f32 v128, v140, v141
    v_cvt_pk_bf16_f32 v129, v142, v143
    v_mul_f32 v140, v114, v84
    v_mul_f32 v141, v114, v85
    v_mul_f32 v142, v114, v86
    v_mul_f32 v143, v114, v87
    v_fmac_f32_dpp v140, v84, v116 quad_perm:[1,0,3,2] row_mask:0xf bank_mask:0xf
    v_fmac_f32_dpp v141, v85, v116 quad_perm:[1,0,3,2] row_mask:0xf bank_mask:0xf
    v_fmac_f32_dpp v142, v86, v116 quad_perm:[1,0,3,2] row_mask:0xf bank_mask:0xf
    v_fmac_f32_dpp v143, v87, v116 quad_perm:[1,0,3,2] row_mask:0xf bank_mask:0xf
    v_cvt_pk_bf16_f32 v130, v140, v141
    v_cvt_pk_bf16_f32 v131, v142, v143
    v_mul_f32 v140, v114, v88
    v_mul_f32 v141, v114, v89
    v_mul_f32 v142, v114, v90
    v_mul_f32 v143, v114, v91
    v_fmac_f32_dpp v140, v88, v116 quad_perm:[1,0,3,2] row_mask:0xf bank_mask:0xf
    v_fmac_f32_dpp v141, v89, v116 quad_perm:[1,0,3,2] row_mask:0xf bank_mask:0xf
    v_fmac_f32_dpp v142, v90, v116 quad_perm:[1,0,3,2] row_mask:0xf bank_mask:0xf
    v_fmac_f32_dpp v143, v91, v116 quad_perm:[1,0,3,2] row_mask:0xf bank_mask:0xf
    v_cvt_pk_bf16_f32 v132, v140, v141
    v_cvt_pk_bf16_f32 v133, v142, v143
    v_mul_f32 v140, v114, v92
    v_mul_f32 v141, v114, v93
    v_mul_f32 v142, v114, v94
    v_mul_f32 v143, v114, v95
    v_fmac_f32_dpp v140, v92, v116 quad_perm:[1,0,3,2] row_mask:0xf bank_mask:0xf
    v_fmac_f32_dpp v141, v93, v116 quad_perm:[1,0,3,2] row_mask:0xf bank_mask:0xf
    v_fmac_f32_dpp v142, v94, v116 quad_perm:[1,0,3,2] row_mask:0xf bank_mask:0xf
    v_fmac_f32_dpp v143, v95, v116 quad_perm:[1,0,3,2] row_mask:0xf bank_mask:0xf
    v_cvt_pk_bf16_f32 v134, v140, v141
    v_cvt_pk_bf16_f32 v135, v142, v143
    s_add_u32 s57, s56, 4096
    s_cmp_eq_u32 s3, 0
    s_cbranch_scc1 Lfar_16
    buffer_store_dwordx4 v[120:123], v99, s[16:19], s56 offen offset:0
    buffer_store_dwordx4 v[124:127], v101, s[16:19], s56 offen offset:1024
    buffer_store_dwordx4 v[128:131], v99, s[16:19], s57 offen
    buffer_store_dwordx4 v[132:135], v101, s[16:19], s57 offen offset:1024
    s_branch Ljoin_17
Lfar_16:
    buffer_store_dwordx4 v[120:123], v99, s[16:19], s56 offen offset:0 sc1
    buffer_store_dwordx4 v[124:127], v101, s[16:19], s56 offen offset:1024 sc1
    buffer_store_dwordx4 v[128:131], v99, s[16:19], s57 offen sc1
    buffer_store_dwordx4 v[132:135], v101, s[16:19], s57 offen offset:1024 sc1
Ljoin_17:
    s_setprio 1
    s_add_u32 s74, s70, 1
    s_and_b32 s74, s74, 7
    s_lshl_b32 s75, s74, 14
    s_add_u32 s75, s75, s60
    s_lshl_b32 s74, s74, 7
    s_add_u32 s74, s74, s62
    s_add_u32 m0, s63, 32768
    s_add_u32 s7, s74, 0
    buffer_load_dwordx4 v7, s[36:39], s7 offen lds
    s_add_u32 m0, s63, 33792
    s_add_u32 s7, s74, 8192
    buffer_load_dwordx4 v8, s[36:39], s7 offen lds
    s_add_u32 m0, s63, 40960
    s_add_u32 s7, s74, 0
    buffer_load_dwordx4 v7, s[40:43], s7 offen lds
    s_add_u32 m0, s63, 41984
    s_add_u32 s7, s74, 8192
    buffer_load_dwordx4 v8, s[40:43], s7 offen lds
    s_barrier
    s_lshl_b32 s58, s5, 4
    s_add_u32 s58, s58, s6
    s_lshl_b32 s58, s58, 2
    s_add_u32 s58, s58, s59
    s_lshl_b32 s58, s58, 2
    s_add_u32 s58, s58, 13713408
    s_waitcnt vmcnt(4)
    s_cmp_eq_u32 s3, 0
    s_cbranch_scc1 Lfar_19
    v_mov_b32 v14, s69
    v_mov_b32 v15, 0
    s_mov_b64 exec, 1
    buffer_store_dword v14, v15, s[16:19], s58 offen
    s_mov_b64 exec, -1
    s_branch Ljoin_20
Lfar_19:
    v_mov_b32 v14, s69
    v_mov_b32 v15, 0
    s_mov_b64 exec, 1
    buffer_store_dword v14, v15, s[16:19], s58 offen sc1
    s_mov_b64 exec, -1
Ljoin_20:
    s_add_u32 s56, s70, 2
    s_and_b32 s56, s56, 7
    s_lshl_b32 s57, s56, 14
    s_add_u32 s57, s57, s60
    s_lshl_b32 s56, s56, 7
    s_add_u32 s56, s56, s62
    s_add_u32 m0, s63, 65536
    s_add_u32 s7, s56, 0
    buffer_load_dwordx4 v7, s[36:39], s7 offen lds
    s_add_u32 m0, s63, 66560
    s_add_u32 s7, s56, 8192
    buffer_load_dwordx4 v8, s[36:39], s7 offen lds
    s_add_u32 m0, s63, 73728
    s_add_u32 s7, s56, 0
    buffer_load_dwordx4 v7, s[40:43], s7 offen lds
    s_add_u32 m0, s63, 74752
    s_add_u32 s7, s56, 8192
    buffer_load_dwordx4 v8, s[40:43], s7 offen lds
    v_bfe_u32 v2, v1, 2, 2
    v_lshlrev_b32 v2, 1, v2
    v_bfe_u32 v3, v1, 4, 1
    v_add_u32 v2, v2, v3
    v_lshrrev_b32 v3, 5, v1
    v_lshl_add_u32 v2, v3, 5, v2
    v_lshlrev_b32 v2, 4, v2
    v_and_b32 v3, 1, v1
    v_lshl_add_u32 v2, v3, 3, v2
    v_bfe_u32 v3, v1, 1, 1
    v_lshl_add_u32 v2, v3, 10, v2
    s_and_b32 s7, s59, 1
    s_lshl_b32 s7, s7, 11
    s_add_u32 s7, s7, 65536
    v_add_u32 v2, s7, v2
    v_lshl_add_u32 v16, v3, 7, v2
    v_xor_b32 v3, 1, v3
    v_lshl_add_u32 v17, v3, 7, v2
    v_add_u32 v18, 65536, v16
    v_add_u32 v19, 65536, v17
    v_and_b32 v2, 31, v1
    v_lshrrev_b32 v3, 1, v2
    v_and_b32 v3, 7, v3
    v_lshlrev_b32 v2, 7, v2
    v_lshrrev_b32 v4, 5, v1
    v_lshl_add_u32 v2, v4, 13, v2
    s_lshr_b32 s7, s59, 1
    s_lshl_b32 s7, s7, 12
    s_add_u32 s7, s7, 81920
    v_add_u32 v2, s7, v2
    v_xor_b32 v4, 0, v3
    v_lshl_add_u32 v20, v4, 4, v2
    v_add_u32 v28, 65536, v20
    v_xor_b32 v4, 1, v3
    v_lshl_add_u32 v21, v4, 4, v2
    v_add_u32 v29, 65536, v21
    v_xor_b32 v4, 2, v3
    v_lshl_add_u32 v22, v4, 4, v2
    v_add_u32 v30, 65536, v22
    v_xor_b32 v4, 3, v3
    v_lshl_add_u32 v23, v4, 4, v2
    v_add_u32 v31, 65536, v23
    v_xor_b32 v4, 4, v3
    v_lshl_add_u32 v24, v4, 4, v2
    v_add_u32 v32, 65536, v24
    v_xor_b32 v4, 5, v3
    v_lshl_add_u32 v25, v4, 4, v2
    v_add_u32 v33, 65536, v25
    v_xor_b32 v4, 6, v3
    v_lshl_add_u32 v26, v4, 4, v2
    v_add_u32 v34, 65536, v26
    v_xor_b32 v4, 7, v3
    v_lshl_add_u32 v27, v4, 4, v2
    v_add_u32 v35, 65536, v27
    s_cmp_lg_u32 s59, 2
    s_cbranch_scc1 Ltwo_22
    s_lshr_b32 s7, s5, 1
    s_lshl_b32 s7, s7, 7
    s_lshl_b32 s56, s6, 15
    s_add_u32 s7, s7, s56
    s_mov_b64 exec, 0xffffffff
    v_lshlrev_b32 v15, 10, v1
    buffer_load_dword v162, v15, s[44:47], s7 offen
    s_mov_b64 exec, -1
Ltwo_22:
    v_and_b32 v13, 15, v1
    v_lshlrev_b32 v13, 4, v13
    v_bfe_u32 v14, v1, 4, 1
    v_lshl_add_u32 v13, v14, 2, v13
    s_lshl_b32 s58, s5, 8
    s_and_b32 s7, s6, 1
    s_lshl_b32 s7, s7, 3
    s_add_u32 s58, s58, s7
    s_add_u32 s58, s58, 13713408
    s_barrier
    buffer_load_dword v14, v13, s[16:19], s58 offen sc1
    s_waitcnt vmcnt(0)
    v_cmp_ne_u32 vcc, s69, v14
    s_nop 3
    s_cbranch_vccz Lpolled_24
    s_mov_b32 s71, 40000
Lpoll_23:
    buffer_load_dword v14, v13, s[16:19], s58 offen sc1
    s_waitcnt vmcnt(0)
    v_cmp_ne_u32 vcc, s69, v14
    s_nop 3
    s_cbranch_vccz Lpolled_24
    s_sub_u32 s71, s71, 1
    s_cmp_eq_u32 s71, 0
    s_cbranch_scc1 Lpolled_24
    s_sleep 1
    s_branch Lpoll_23
Lpolled_24:
    s_add_u32 s56, s70, 0
    s_and_b32 s56, s56, 7
    s_lshl_b32 s57, s56, 14
    s_add_u32 s57, s57, s60
    s_lshl_b32 s56, s56, 7
    s_add_u32 s56, s56, s62
    s_add_u32 m0, s61, 0
    s_add_u32 s7, s57, 0
    buffer_load_dwordx4 v11, s[16:19], s7 offen sc1 lds
    s_add_u32 m0, s61, 1024
    s_add_u32 s7, s57, 1024
    buffer_load_dwordx4 v11, s[16:19], s7 offen sc1 lds
    s_add_u32 m0, s61, 2048
    s_add_u32 s7, s57, 2048
    buffer_load_dwordx4 v11, s[16:19], s7 offen sc1 lds
    s_add_u32 m0, s61, 3072
    s_add_u32 s7, s57, 3072
    buffer_load_dwordx4 v11, s[16:19], s7 offen sc1 lds
    s_add_u32 s74, s70, 1
    s_and_b32 s74, s74, 7
    s_lshl_b32 s75, s74, 14
    s_add_u32 s75, s75, s60
    s_lshl_b32 s74, s74, 7
    s_add_u32 s74, s74, s62
    s_add_u32 m0, s61, 32768
    s_add_u32 s7, s75, 0
    buffer_load_dwordx4 v11, s[16:19], s7 offen sc1 lds
    s_add_u32 m0, s61, 33792
    s_add_u32 s7, s75, 1024
    buffer_load_dwordx4 v11, s[16:19], s7 offen sc1 lds
    s_add_u32 m0, s61, 34816
    s_add_u32 s7, s75, 2048
    buffer_load_dwordx4 v11, s[16:19], s7 offen sc1 lds
    s_add_u32 m0, s61, 35840
    s_add_u32 s7, s75, 3072
    buffer_load_dwordx4 v11, s[16:19], s7 offen sc1 lds
    s_add_u32 s56, s70, 2
    s_and_b32 s56, s56, 7
    s_lshl_b32 s57, s56, 14
    s_add_u32 s57, s57, s60
    s_lshl_b32 s56, s56, 7
    s_add_u32 s56, s56, s62
    s_add_u32 m0, s61, 65536
    s_add_u32 s7, s57, 0
    buffer_load_dwordx4 v11, s[16:19], s7 offen sc1 lds
    s_add_u32 m0, s61, 66560
    s_add_u32 s7, s57, 1024
    buffer_load_dwordx4 v11, s[16:19], s7 offen sc1 lds
    s_add_u32 m0, s61, 67584
    s_add_u32 s7, s57, 2048
    buffer_load_dwordx4 v11, s[16:19], s7 offen sc1 lds
    s_add_u32 m0, s61, 68608
    s_add_u32 s7, s57, 3072
    buffer_load_dwordx4 v11, s[16:19], s7 offen sc1 lds
    s_waitcnt vmcnt(8)
    s_barrier
    v_and_b32 v13, 15, v1
    v_lshlrev_b32 v13, 9, v13
    v_bfe_u32 v14, v1, 4, 1
    v_lshl_add_u32 v13, v14, 7, v13
    s_lshl_b32 s58, s6, 13
    s_and_b32 s7, s5, 1
    s_lshl_b32 s7, s7, 8
    s_add_u32 s58, s58, s7
    s_add_u32 s58, s58, 13762560
    buffer_load_dword v14, v13, s[16:19], s58 offen sc1
    ds_read_b64_tr_b16 v[36:37], v16 offset:0
    ds_read_b64_tr_b16 v[38:39], v17 offset:0
    ds_read_b128 v[48:51], v20 offset:0
    ds_read_b64_tr_b16 v[40:41], v16 offset:256
    ds_read_b64_tr_b16 v[42:43], v17 offset:256
    ds_read_b128 v[52:55], v21 offset:0
    ds_read_b64_tr_b16 v[44:45], v16 offset:4096
    ds_read_b64_tr_b16 v[46:47], v17 offset:4096
    ds_read_b128 v[56:59], v22 offset:0
    ds_read_b64_tr_b16 v[120:121], v16 offset:4352
    ds_read_b64_tr_b16 v[122:123], v17 offset:4352
    ds_read_b128 v[128:131], v23 offset:0
    ds_read_b64_tr_b16 v[124:125], v16 offset:8192
    ds_read_b64_tr_b16 v[126:127], v17 offset:8192
    ds_read_b128 v[132:135], v24 offset:0
    s_waitcnt lgkmcnt(12)
    v_mfma_f32_32x32x16_bf16 v[64:79], v[36:39], v[48:51], 0
    ds_read_b64_tr_b16 v[36:37], v16 offset:8448
    ds_read_b64_tr_b16 v[38:39], v17 offset:8448
    ds_read_b128 v[48:51], v25 offset:0
    s_waitcnt lgkmcnt(12)
    v_mfma_f32_32x32x16_bf16 v[64:79], v[40:43], v[52:55], v[64:79]
    ds_read_b64_tr_b16 v[40:41], v16 offset:12288
    ds_read_b64_tr_b16 v[42:43], v17 offset:12288
    ds_read_b128 v[52:55], v26 offset:0
    s_waitcnt lgkmcnt(12)
    v_mfma_f32_32x32x16_bf16 v[64:79], v[44:47], v[56:59], v[64:79]
    ds_read_b64_tr_b16 v[44:45], v16 offset:12544
    ds_read_b64_tr_b16 v[46:47], v17 offset:12544
    ds_read_b128 v[56:59], v27 offset:0
    s_waitcnt lgkmcnt(12)
    v_mfma_f32_32x32x16_bf16 v[64:79], v[120:123], v[128:131], v[64:79]
    s_waitcnt lgkmcnt(9)
    v_mfma_f32_32x32x16_bf16 v[64:79], v[124:127], v[132:135], v[64:79]
    s_waitcnt lgkmcnt(6)
    v_mfma_f32_32x32x16_bf16 v[64:79], v[36:39], v[48:51], v[64:79]
    s_waitcnt lgkmcnt(3)
    v_mfma_f32_32x32x16_bf16 v[64:79], v[40:43], v[52:55], v[64:79]
    s_waitcnt lgkmcnt(0)
    v_mfma_f32_32x32x16_bf16 v[64:79], v[44:47], v[56:59], v[64:79]
    s_waitcnt vmcnt(5)
    s_barrier
    s_waitcnt vmcnt(0)
    v_cmp_ne_u32 vcc, s69, v14
    s_nop 3
    s_cbranch_vccz Lpolled_26
    s_mov_b32 s71, 40000
Lpoll_25:
    buffer_load_dword v14, v13, s[16:19], s58 offen sc1
    s_waitcnt vmcnt(0)
    v_cmp_ne_u32 vcc, s69, v14
    s_nop 3
    s_cbranch_vccz Lpolled_26
    s_sub_u32 s71, s71, 1
    s_cmp_eq_u32 s71, 0
    s_cbranch_scc1 Lpolled_26
    s_sleep 1
    s_branch Lpoll_25
Lpolled_26:
    s_cmp_lg_u32 s2, 0
    s_cbranch_scc1 Lnononce_27
    s_cmp_lg_u32 s59, 0
    s_cbranch_scc1 Lnononce_27
    v_lshlrev_b32 v13, 5, v1
    s_mov_b32 s71, 40000
Lnonce_again_28:
    s_mov_b32 s58, 13697024
    buffer_load_dword v120, v13, s[16:19], s58 offen offset:0 sc1
    buffer_load_dword v121, v13, s[16:19], s58 offen offset:2048 sc1
    s_add_u32 s58, s58, 4096
    buffer_load_dword v122, v13, s[16:19], s58 offen offset:0 sc1
    buffer_load_dword v123, v13, s[16:19], s58 offen offset:2048 sc1
    s_waitcnt vmcnt(0)
    v_xor_b32 v120, s69, v120
    v_xor_b32 v121, s69, v121
    v_xor_b32 v122, s69, v122
    v_xor_b32 v123, s69, v123
    v_or3_b32 v120, v120, v121, v122
    v_or_b32 v120, v120, v123
    v_cmp_ne_u32 vcc, 0, v120
    s_nop 3
    s_cbranch_vccz Lnonce_ok_29
    s_sub_u32 s71, s71, 1
    s_cmp_eq_u32 s71, 0
    s_cbranch_scc1 Lnononce_27
    s_sleep 2
    s_branch Lnonce_again_28
Lnonce_ok_29:
    v_mov_b32 v120, s69
    v_mov_b32 v121, 0
    s_mov_b32 s7, 13631488
    s_mov_b64 exec, 1
    buffer_store_dword v120, v121, s[16:19], s7 offen sc1
    s_mov_b64 exec, -1
Lnononce_27:
    s_add_u32 s74, s70, 3
    s_and_b32 s74, s74, 7
    s_lshl_b32 s75, s74, 14
    s_add_u32 s75, s75, s60
    s_lshl_b32 s74, s74, 7
    s_add_u32 s74, s74, s62
    s_add_u32 m0, s63, 0
    s_add_u32 s7, s74, 0
    buffer_load_dwordx4 v7, s[36:39], s7 offen lds
    ds_read_b64_tr_b16 v[36:37], v16 offset:32768
    ds_read_b64_tr_b16 v[38:39], v17 offset:32768
    ds_read_b128 v[48:51], v20 offset:32768
    ds_read_b64_tr_b16 v[40:41], v16 offset:33024
    ds_read_b64_tr_b16 v[42:43], v17 offset:33024
    ds_read_b128 v[52:55], v21 offset:32768
    ds_read_b64_tr_b16 v[44:45], v16 offset:36864
    ds_read_b64_tr_b16 v[46:47], v17 offset:36864
    ds_read_b128 v[56:59], v22 offset:32768
    ds_read_b64_tr_b16 v[120:121], v16 offset:37120
    ds_read_b64_tr_b16 v[122:123], v17 offset:37120
    ds_read_b128 v[128:131], v23 offset:32768
    s_add_u32 m0, s63, 1024
    s_add_u32 s7, s74, 8192
    buffer_load_dwordx4 v8, s[36:39], s7 offen lds
    ds_read_b64_tr_b16 v[124:125], v16 offset:40960
    ds_read_b64_tr_b16 v[126:127], v17 offset:40960
    ds_read_b128 v[132:135], v24 offset:32768
    s_waitcnt lgkmcnt(12)
    v_mfma_f32_32x32x16_bf16 v[64:79], v[36:39], v[48:51], v[64:79]
    s_add_u32 m0, s63, 8192
    s_add_u32 s7, s74, 0
    buffer_load_dwordx4 v7, s[40:43], s7 offen lds
    ds_read_b64_tr_b16 v[36:37], v16 offset:41216
    ds_read_b64_tr_b16 v[38:39], v17 offset:41216
    ds_read_b128 v[48:51], v25 offset:32768
    s_waitcnt lgkmcnt(12)
    v_mfma_f32_32x32x16_bf16 v[64:79], v[40:43], v[52:55], v[64:79]
    s_add_u32 m0, s63, 9216
    s_add_u32 s7, s74, 8192
    buffer_load_dwordx4 v8, s[40:43], s7 offen lds
    s_add_u32 m0, s61, 0
    s_add_u32 s7, s75, 0
    buffer_load_dwordx4 v11, s[16:19], s7 offen sc1 lds
    ds_read_b64_tr_b16 v[40:41], v16 offset:45056
    ds_read_b64_tr_b16 v[42:43], v17 offset:45056
    ds_read_b128 v[52:55], v26 offset:32768
    s_waitcnt lgkmcnt(12)
    v_mfma_f32_32x32x16_bf16 v[64:79], v[44:47], v[56:59], v[64:79]
    s_add_u32 m0, s61, 1024
    s_add_u32 s7, s75, 1024
    buffer_load_dwordx4 v11, s[16:19], s7 offen sc1 lds
    ds_read_b64_tr_b16 v[44:45], v16 offset:45312
    ds_read_b64_tr_b16 v[46:47], v17 offset:45312
    ds_read_b128 v[56:59], v27 offset:32768
    s_waitcnt lgkmcnt(12)
    v_mfma_f32_32x32x16_bf16 v[64:79], v[120:123], v[128:131], v[64:79]
    s_add_u32 m0, s61, 2048
    s_add_u32 s7, s75, 2048
    buffer_load_dwordx4 v11, s[16:19], s7 offen sc1 lds
    s_waitcnt lgkmcnt(9)
    v_mfma_f32_32x32x16_bf16 v[64:79], v[124:127], v[132:135], v[64:79]
    s_add_u32 m0, s61, 3072
    s_add_u32 s7, s75, 3072
    buffer_load_dwordx4 v11, s[16:19], s7 offen sc1 lds
    s_lshr_b32 s64, s5, 1
    s_lshl_b32 s64, s64, 7
    s_lshl_b32 s65, s59, 16
    s_add_u32 s64, s64, s65
    s_lshl_b32 s65, s59, 12
    s_add_u32 m0, s65, 0
    s_add_u32 s7, s64, 0
    buffer_load_dwordx4 v12, s[44:47], s7 offen lds
    s_waitcnt lgkmcnt(6)
    v_mfma_f32_32x32x16_bf16 v[64:79], v[36:39], v[48:51], v[64:79]
    s_add_u32 m0, s65, 1024
    s_add_u32 s7, s64, 16384
    buffer_load_dwordx4 v12, s[44:47], s7 offen lds
    s_waitcnt lgkmcnt(3)
    v_mfma_f32_32x32x16_bf16 v[64:79], v[40:43], v[52:55], v[64:79]
    s_add_u32 m0, s65, 2048
    s_add_u32 s7, s64, 32768
    buffer_load_dwordx4 v12, s[44:47], s7 offen lds
    s_waitcnt lgkmcnt(0)
    v_mfma_f32_32x32x16_bf16 v[64:79], v[44:47], v[56:59], v[64:79]
    s_add_u32 m0, s65, 3072
    s_add_u32 s7, s64, 49152
    buffer_load_dwordx4 v12, s[44:47], s7 offen lds
    s_barrier
    s_add_u32 s56, s70, 4
    s_and_b32 s56, s56, 7
    s_lshl_b32 s57, s56, 14
    s_add_u32 s57, s57, s60
    s_lshl_b32 s56, s56, 7
    s_add_u32 s56, s56, s62
    s_add_u32 m0, s63, 32768
    s_add_u32 s7, s56, 0
    buffer_load_dwordx4 v7, s[36:39], s7 offen lds
    ds_read_b64_tr_b16 v[36:37], v18 offset:0
    ds_read_b64_tr_b16 v[38:39], v19 offset:0
    ds_read_b128 v[48:51], v28 offset:0
    ds_read_b64_tr_b16 v[40:41], v18 offset:256
    ds_read_b64_tr_b16 v[42:43], v19 offset:256
    ds_read_b128 v[52:55], v29 offset:0
    ds_read_b64_tr_b16 v[44:45], v18 offset:4096
    ds_read_b64_tr_b16 v[46:47], v19 offset:4096
    ds_read_b128 v[56:59], v30 offset:0
    ds_read_b64_tr_b16 v[120:121], v18 offset:4352
    ds_read_b64_tr_b16 v[122:123], v19 offset:4352
    ds_read_b128 v[128:131], v31 offset:0
    s_add_u32 m0, s63, 33792
    s_add_u32 s7, s56, 8192
    buffer_load_dwordx4 v8, s[36:39], s7 offen lds
    ds_read_b64_tr_b16 v[124:125], v18 offset:8192
    ds_read_b64_tr_b16 v[126:127], v19 offset:8192
    ds_read_b128 v[132:135], v32 offset:0
    s_waitcnt lgkmcnt(12)
    v_mfma_f32_32x32x16_bf16 v[64:79], v[36:39], v[48:51], v[64:79]
    s_add_u32 m0, s63, 40960
    s_add_u32 s7, s56, 0
    buffer_load_dwordx4 v7, s[40:43], s7 offen lds
    ds_read_b64_tr_b16 v[36:37], v18 offset:8448
    ds_read_b64_tr_b16 v[38:39], v19 offset:8448
    ds_read_b128 v[48:51], v33 offset:0
    s_waitcnt lgkmcnt(12)
    v_mfma_f32_32x32x16_bf16 v[64:79], v[40:43], v[52:55], v[64:79]
    s_add_u32 m0, s63, 41984
    s_add_u32 s7, s56, 8192
    buffer_load_dwordx4 v8, s[40:43], s7 offen lds
    s_add_u32 m0, s61, 32768
    s_add_u32 s7, s57, 0
    buffer_load_dwordx4 v11, s[16:19], s7 offen sc1 lds
    ds_read_b64_tr_b16 v[40:41], v18 offset:12288
    ds_read_b64_tr_b16 v[42:43], v19 offset:12288
    ds_read_b128 v[52:55], v34 offset:0
    s_waitcnt lgkmcnt(12)
    v_mfma_f32_32x32x16_bf16 v[64:79], v[44:47], v[56:59], v[64:79]
    s_add_u32 m0, s61, 33792
    s_add_u32 s7, s57, 1024
    buffer_load_dwordx4 v11, s[16:19], s7 offen sc1 lds
    ds_read_b64_tr_b16 v[44:45], v18 offset:12544
    ds_read_b64_tr_b16 v[46:47], v19 offset:12544
    ds_read_b128 v[56:59], v35 offset:0
    s_waitcnt lgkmcnt(12)
    v_mfma_f32_32x32x16_bf16 v[64:79], v[120:123], v[128:131], v[64:79]
    s_add_u32 m0, s61, 34816
    s_add_u32 s7, s57, 2048
    buffer_load_dwordx4 v11, s[16:19], s7 offen sc1 lds
    s_waitcnt lgkmcnt(9)
    v_mfma_f32_32x32x16_bf16 v[64:79], v[124:127], v[132:135], v[64:79]
    s_add_u32 m0, s61, 35840
    s_add_u32 s7, s57, 3072
    buffer_load_dwordx4 v11, s[16:19], s7 offen sc1 lds
    s_lshr_b32 s64, s5, 1
    s_lshl_b32 s64, s64, 7
    s_lshl_b32 s65, s59, 16
    s_add_u32 s64, s64, s65
    s_lshl_b32 s65, s59, 12
    s_add_u32 m0, s65, 16384
    s_add_u32 s7, s64, 262144
    buffer_load_dwordx4 v12, s[44:47], s7 offen lds
    s_waitcnt lgkmcnt(6)
    v_mfma_f32_32x32x16_bf16 v[64:79], v[36:39], v[48:51], v[64:79]
    s_add_u32 m0, s65, 17408
    s_add_u32 s7, s64, 278528
    buffer_load_dwordx4 v12, s[44:47], s7 offen lds
    s_waitcnt lgkmcnt(3)
    v_mfma_f32_32x32x16_bf16 v[64:79], v[40:43], v[52:55], v[64:79]
    s_add_u32 m0, s65, 18432
    s_add_u32 s7, s64, 294912
    buffer_load_dwordx4 v12, s[44:47], s7 offen lds
    s_waitcnt lgkmcnt(0)
    v_mfma_f32_32x32x16_bf16 v[64:79], v[44:47], v[56:59], v[64:79]
    s_add_u32 m0, s65, 19456
    s_add_u32 s7, s64, 311296
    buffer_load_dwordx4 v12, s[44:47], s7 offen lds
    s_waitcnt vmcnt(16)
    s_barrier
    s_add_u32 s74, s70, 5
    s_and_b32 s74, s74, 7
    s_lshl_b32 s75, s74, 14
    s_add_u32 s75, s75, s60
    s_lshl_b32 s74, s74, 7
    s_add_u32 s74, s74, s62
    s_add_u32 m0, s63, 65536
    s_add_u32 s7, s74, 0
    buffer_load_dwordx4 v7, s[36:39], s7 offen lds
    ds_read_b64_tr_b16 v[36:37], v16 offset:0
    ds_read_b64_tr_b16 v[38:39], v17 offset:0
    ds_read_b128 v[48:51], v20 offset:0
    ds_read_b64_tr_b16 v[40:41], v16 offset:256
    ds_read_b64_tr_b16 v[42:43], v17 offset:256
    ds_read_b128 v[52:55], v21 offset:0
    ds_read_b64_tr_b16 v[44:45], v16 offset:4096
    ds_read_b64_tr_b16 v[46:47], v17 offset:4096
    ds_read_b128 v[56:59], v22 offset:0
    ds_read_b64_tr_b16 v[120:121], v16 offset:4352
    ds_read_b64_tr_b16 v[122:123], v17 offset:4352
    ds_read_b128 v[128:131], v23 offset:0
    s_add_u32 m0, s63, 66560
    s_add_u32 s7, s74, 8192
    buffer_load_dwordx4 v8, s[36:39], s7 offen lds
    ds_read_b64_tr_b16 v[124:125], v16 offset:8192
    ds_read_b64_tr_b16 v[126:127], v17 offset:8192
    ds_read_b128 v[132:135], v24 offset:0
    s_waitcnt lgkmcnt(12)
    v_mfma_f32_32x32x16_bf16 v[64:79], v[36:39], v[48:51], v[64:79]
    s_add_u32 m0, s63, 73728
    s_add_u32 s7, s74, 0
    buffer_load_dwordx4 v7, s[40:43], s7 offen lds
    ds_read_b64_tr_b16 v[36:37], v16 offset:8448
    ds_read_b64_tr_b16 v[38:39], v17 offset:8448
    ds_read_b128 v[48:51], v25 offset:0
    s_waitcnt lgkmcnt(12)
    v_mfma_f32_32x32x16_bf16 v[64:79], v[40:43], v[52:55], v[64:79]
    s_add_u32 m0, s63, 74752
    s_add_u32 s7, s74, 8192
    buffer_load_dwordx4 v8, s[40:43], s7 offen lds
    s_add_u32 m0, s61, 65536
    s_add_u32 s7, s75, 0
    buffer_load_dwordx4 v11, s[16:19], s7 offen sc1 lds
    ds_read_b64_tr_b16 v[40:41], v16 offset:12288
    ds_read_b64_tr_b16 v[42:43], v17 offset:12288
    ds_read_b128 v[52:55], v26 offset:0
    s_waitcnt lgkmcnt(12)
    v_mfma_f32_32x32x16_bf16 v[64:79], v[44:47], v[56:59], v[64:79]
    s_add_u32 m0, s61, 66560
    s_add_u32 s7, s75, 1024
    buffer_load_dwordx4 v11, s[16:19], s7 offen sc1 lds
    ds_read_b64_tr_b16 v[44:45], v16 offset:12544
    ds_read_b64_tr_b16 v[46:47], v17 offset:12544
    ds_read_b128 v[56:59], v27 offset:0
    s_waitcnt lgkmcnt(12)
    v_mfma_f32_32x32x16_bf16 v[64:79], v[120:123], v[128:131], v[64:79]
    s_add_u32 m0, s61, 67584
    s_add_u32 s7, s75, 2048
    buffer_load_dwordx4 v11, s[16:19], s7 offen sc1 lds
    s_waitcnt lgkmcnt(9)
    v_mfma_f32_32x32x16_bf16 v[64:79], v[124:127], v[132:135], v[64:79]
    s_add_u32 m0, s61, 68608
    s_add_u32 s7, s75, 3072
    buffer_load_dwordx4 v11, s[16:19], s7 offen sc1 lds
    s_lshr_b32 s64, s5, 1
    s_lshl_b32 s64, s64, 7
    s_lshl_b32 s65, s59, 16
    s_add_u32 s64, s64, s65
    s_lshl_b32 s65, s59, 12
    s_add_u32 m0, s65, 32768
    s_add_u32 s7, s64, 64
    buffer_load_dwordx4 v12, s[44:47], s7 offen lds
    s_waitcnt lgkmcnt(6)
    v_mfma_f32_32x32x16_bf16 v[64:79], v[36:39], v[48:51], v[64:79]
    s_add_u32 m0, s65, 33792
    s_add_u32 s7, s64, 16448
    buffer_load_dwordx4 v12, s[44:47], s7 offen lds
    s_waitcnt lgkmcnt(3)
    v_mfma_f32_32x32x16_bf16 v[64:79], v[40:43], v[52:55], v[64:79]
    s_add_u32 m0, s65, 34816
    s_add_u32 s7, s64, 32832
    buffer_load_dwordx4 v12, s[44:47], s7 offen lds
    s_waitcnt lgkmcnt(0)
    v_mfma_f32_32x32x16_bf16 v[64:79], v[44:47], v[56:59], v[64:79]
    s_add_u32 m0, s65, 35840
    s_add_u32 s7, s64, 49216
    buffer_load_dwordx4 v12, s[44:47], s7 offen lds
    s_waitcnt vmcnt(16)
    s_barrier
    s_lshr_b32 s64, s5, 1
    s_lshl_b32 s64, s64, 7
    s_lshl_b32 s65, s59, 16
    s_add_u32 s64, s64, s65
    s_lshl_b32 s65, s59, 12
    s_add_u32 m0, s65, 49152
    s_add_u32 s7, s64, 262208
    buffer_load_dwordx4 v12, s[44:47], s7 offen lds
    ds_read_b64_tr_b16 v[36:37], v16 offset:32768
    ds_read_b64_tr_b16 v[38:39], v17 offset:32768
    ds_read_b128 v[48:51], v20 offset:32768
    ds_read_b64_tr_b16 v[40:41], v16 offset:33024
    ds_read_b64_tr_b16 v[42:43], v17 offset:33024
    ds_read_b128 v[52:55], v21 offset:32768
    ds_read_b64_tr_b16 v[44:45], v16 offset:36864
    ds_read_b64_tr_b16 v[46:47], v17 offset:36864
    ds_read_b128 v[56:59], v22 offset:32768
    ds_read_b64_tr_b16 v[120:121], v16 offset:37120
    ds_read_b64_tr_b16 v[122:123], v17 offset:37120
    ds_read_b128 v[128:131], v23 offset:32768
    s_add_u32 m0, s65, 50176
    s_add_u32 s7, s64, 278592
    buffer_load_dwordx4 v12, s[44:47], s7 offen lds
    ds_read_b64_tr_b16 v[124:125], v16 offset:40960
    ds_read_b64_tr_b16 v[126:127], v17 offset:40960
    ds_read_b128 v[132:135], v24 offset:32768
    s_waitcnt lgkmcnt(12)
    v_mfma_f32_32x32x16_bf16 v[64:79], v[36:39], v[48:51], v[64:79]
    s_add_u32 m0, s65, 51200
    s_add_u32 s7, s64, 294976
    buffer_load_dwordx4 v12, s[44:47], s7 offen lds
    ds_read_b64_tr_b16 v[36:37], v16 offset:41216
    ds_read_b64_tr_b16 v[38:39], v17 offset:41216
    ds_read_b128 v[48:51], v25 offset:32768
    s_waitcnt lgkmcnt(12)
    v_mfma_f32_32x32x16_bf16 v[64:79], v[40:43], v[52:55], v[64:79]
    s_add_u32 m0, s65, 52224
    s_add_u32 s7, s64, 311360
    buffer_load_dwordx4 v12, s[44:47], s7 offen lds
    s_add_u32 s56, s70, 6
    s_and_b32 s56, s56, 7
    s_lshl_b32 s57, s56, 14
    s_add_u32 s57, s57, s60
    s_lshl_b32 s56, s56, 7
    s_add_u32 s56, s56, s62
    s_add_u32 m0, s63, 0
    s_add_u32 s7, s56, 0
    buffer_load_dwordx4 v7, s[36:39], s7 offen lds
    ds_read_b64_tr_b16 v[40:41], v16 offset:45056
    ds_read_b64_tr_b16 v[42:43], v17 offset:45056
    ds_read_b128 v[52:55], v26 offset:32768
    s_waitcnt lgkmcnt(12)
    v_mfma_f32_32x32x16_bf16 v[64:79], v[44:47], v[56:59], v[64:79]
    s_add_u32 m0, s63, 1024
    s_add_u32 s7, s56, 8192
    buffer_load_dwordx4 v8, s[36:39], s7 offen lds
    ds_read_b64_tr_b16 v[44:45], v16 offset:45312
    ds_read_b64_tr_b16 v[46:47], v17 offset:45312
    ds_read_b128 v[56:59], v27 offset:32768
    s_waitcnt lgkmcnt(12)
    v_mfma_f32_32x32x16_bf16 v[64:79], v[120:123], v[128:131], v[64:79]
    s_add_u32 m0, s63, 8192
    s_add_u32 s7, s56, 0
    buffer_load_dwordx4 v7, s[40:43], s7 offen lds
    s_waitcnt lgkmcnt(9)
    v_mfma_f32_32x32x16_bf16 v[64:79], v[124:127], v[132:135], v[64:79]
    s_add_u32 m0, s63, 9216
    s_add_u32 s7, s56, 8192
    buffer_load_dwordx4 v8, s[40:43], s7 offen lds
    s_add_u32 m0, s61, 0
    s_add_u32 s7, s57, 0
    buffer_load_dwordx4 v11, s[16:19], s7 offen sc1 lds
    s_waitcnt lgkmcnt(6)
    v_mfma_f32_32x32x16_bf16 v[64:79], v[36:39], v[48:51], v[64:79]
    s_add_u32 m0, s61, 1024
    s_add_u32 s7, s57, 1024
    buffer_load_dwordx4 v11, s[16:19], s7 offen sc1 lds
    s_waitcnt lgkmcnt(3)
    v_mfma_f32_32x32x16_bf16 v[64:79], v[40:43], v[52:55], v[64:79]
    s_add_u32 m0, s61, 2048
    s_add_u32 s7, s57, 2048
    buffer_load_dwordx4 v11, s[16:19], s7 offen sc1 lds
    s_waitcnt lgkmcnt(0)
    v_mfma_f32_32x32x16_bf16 v[64:79], v[44:47], v[56:59], v[64:79]
    s_add_u32 m0, s61, 3072
    s_add_u32 s7, s57, 3072
    buffer_load_dwordx4 v11, s[16:19], s7 offen sc1 lds
    s_waitcnt vmcnt(16)
    s_barrier
    ds_read_b64_tr_b16 v[36:37], v18 offset:0
    ds_read_b64_tr_b16 v[38:39], v19 offset:0
    ds_read_b128 v[48:51], v28 offset:0
    ds_read_b64_tr_b16 v[40:41], v18 offset:256
    ds_read_b64_tr_b16 v[42:43], v19 offset:256
    ds_read_b128 v[52:55], v29 offset:0
    ds_read_b64_tr_b16 v[44:45], v18 offset:4096
    ds_read_b64_tr_b16 v[46:47], v19 offset:4096
    ds_read_b128 v[56:59], v30 offset:0
    ds_read_b64_tr_b16 v[120:121], v18 offset:4352
    ds_read_b64_tr_b16 v[122:123], v19 offset:4352
    ds_read_b128 v[128:131], v31 offset:0
    s_add_u32 s74, s70, 7
    s_and_b32 s74, s74, 7
    s_lshl_b32 s75, s74, 14
    s_add_u32 s75, s75, s60
    s_lshl_b32 s74, s74, 7
    s_add_u32 s74, s74, s62
    s_add_u32 m0, s63, 32768
    s_add_u32 s7, s74, 0
    buffer_load_dwordx4 v7, s[36:39], s7 offen lds
    ds_read_b64_tr_b16 v[124:125], v18 offset:8192
    ds_read_b64_tr_b16 v[126:127], v19 offset:8192
    ds_read_b128 v[132:135], v32 offset:0
    s_waitcnt lgkmcnt(12)
    v_mfma_f32_32x32x16_bf16 v[64:79], v[36:39], v[48:51], v[64:79]
    s_add_u32 m0, s63, 33792
    s_add_u32 s7, s74, 8192
    buffer_load_dwordx4 v8, s[36:39], s7 offen lds
    ds_read_b64_tr_b16 v[36:37], v18 offset:8448
    ds_read_b64_tr_b16 v[38:39], v19 offset:8448
    ds_read_b128 v[48:51], v33 offset:0
    s_waitcnt lgkmcnt(12)
    v_mfma_f32_32x32x16_bf16 v[64:79], v[40:43], v[52:55], v[64:79]
    s_add_u32 m0, s63, 40960
    s_add_u32 s7, s74, 0
    buffer_load_dwordx4 v7, s[40:43], s7 offen lds
    ds_read_b64_tr_b16 v[40:41], v18 offset:12288
    ds_read_b64_tr_b16 v[42:43], v19 offset:12288
    ds_read_b128 v[52:55], v34 offset:0
    s_waitcnt lgkmcnt(12)
    v_mfma_f32_32x32x16_bf16 v[64:79], v[44:47], v[56:59], v[64:79]
    s_add_u32 m0, s63, 41984
    s_add_u32 s7, s74, 8192
    buffer_load_dwordx4 v8, s[40:43], s7 offen lds
    ds_read_b64_tr_b16 v[44:45], v18 offset:12544
    ds_read_b64_tr_b16 v[46:47], v19 offset:12544
    ds_read_b128 v[56:59], v35 offset:0
    s_waitcnt lgkmcnt(12)
    v_mfma_f32_32x32x16_bf16 v[64:79], v[120:123], v[128:131], v[64:79]
    s_add_u32 m0, s61, 32768
    s_add_u32 s7, s75, 0
    buffer_load_dwordx4 v11, s[16:19], s7 offen sc1 lds
    s_waitcnt lgkmcnt(9)
    v_mfma_f32_32x32x16_bf16 v[64:79], v[124:127], v[132:135], v[64:79]
    s_add_u32 m0, s61, 33792
    s_add_u32 s7, s75, 1024
    buffer_load_dwordx4 v11, s[16:19], s7 offen sc1 lds
    s_waitcnt lgkmcnt(6)
    v_mfma_f32_32x32x16_bf16 v[64:79], v[36:39], v[48:51], v[64:79]
    s_add_u32 m0, s61, 34816
    s_add_u32 s7, s75, 2048
    buffer_load_dwordx4 v11, s[16:19], s7 offen sc1 lds
    s_waitcnt lgkmcnt(3)
    v_mfma_f32_32x32x16_bf16 v[64:79], v[40:43], v[52:55], v[64:79]
    s_add_u32 m0, s61, 35840
    s_add_u32 s7, s75, 3072
    buffer_load_dwordx4 v11, s[16:19], s7 offen sc1 lds
    s_waitcnt lgkmcnt(0)
    v_mfma_f32_32x32x16_bf16 v[64:79], v[44:47], v[56:59], v[64:79]
    s_waitcnt vmcnt(8)
    s_barrier
    ds_read_b64_tr_b16 v[36:37], v16 offset:0
    ds_read_b64_tr_b16 v[38:39], v17 offset:0
    ds_read_b128 v[48:51], v20 offset:0
    ds_read_b64_tr_b16 v[40:41], v16 offset:256
    ds_read_b64_tr_b16 v[42:43], v17 offset:256
    ds_read_b128 v[52:55], v21 offset:0
    ds_read_b64_tr_b16 v[44:45], v16 offset:4096
    ds_read_b64_tr_b16 v[46:47], v17 offset:4096
    ds_read_b128 v[56:59], v22 offset:0
    ds_read_b64_tr_b16 v[120:121], v16 offset:4352
    ds_read_b64_tr_b16 v[122:123], v17 offset:4352
    ds_read_b128 v[128:131], v23 offset:0
    ds_read_b64_tr_b16 v[124:125], v16 offset:8192
    ds_read_b64_tr_b16 v[126:127], v17 offset:8192
    ds_read_b128 v[132:135], v24 offset:0
    s_waitcnt lgkmcnt(12)
    v_mfma_f32_32x32x16_bf16 v[64:79], v[36:39], v[48:51], v[64:79]
    ds_read_b64_tr_b16 v[36:37], v16 offset:8448
    ds_read_b64_tr_b16 v[38:39], v17 offset:8448
    ds_read_b128 v[48:51], v25 offset:0
    s_waitcnt lgkmcnt(12)
    v_mfma_f32_32x32x16_bf16 v[64:79], v[40:43], v[52:55], v[64:79]
    ds_read_b64_tr_b16 v[40:41], v16 offset:12288
    ds_read_b64_tr_b16 v[42:43], v17 offset:12288
    ds_read_b128 v[52:55], v26 offset:0
    s_waitcnt lgkmcnt(12)
    v_mfma_f32_32x32x16_bf16 v[64:79], v[44:47], v[56:59], v[64:79]
    ds_read_b64_tr_b16 v[44:45], v16 offset:12544
    ds_read_b64_tr_b16 v[46:47], v17 offset:12544
    ds_read_b128 v[56:59], v27 offset:0
    s_waitcnt lgkmcnt(12)
    v_mfma_f32_32x32x16_bf16 v[64:79], v[120:123], v[128:131], v[64:79]
    s_waitcnt lgkmcnt(9)
    v_mfma_f32_32x32x16_bf16 v[64:79], v[124:127], v[132:135], v[64:79]
    s_waitcnt lgkmcnt(6)
    v_mfma_f32_32x32x16_bf16 v[64:79], v[36:39], v[48:51], v[64:79]
    s_waitcnt lgkmcnt(3)
    v_mfma_f32_32x32x16_bf16 v[64:79], v[40:43], v[52:55], v[64:79]
    s_waitcnt lgkmcnt(0)
    v_mfma_f32_32x32x16_bf16 v[64:79], v[44:47], v[56:59], v[64:79]
    s_waitcnt vmcnt(0)
    s_barrier
    ds_read_b64_tr_b16 v[36:37], v16 offset:32768
    ds_read_b64_tr_b16 v[38:39], v17 offset:32768
    ds_read_b128 v[48:51], v20 offset:32768
    ds_read_b64_tr_b16 v[40:41], v16 offset:33024
    ds_read_b64_tr_b16 v[42:43], v17 offset:33024
    ds_read_b128 v[52:55], v21 offset:32768
    ds_read_b64_tr_b16 v[44:45], v16 offset:36864
    ds_read_b64_tr_b16 v[46:47], v17 offset:36864
    ds_read_b128 v[56:59], v22 offset:32768
    ds_read_b64_tr_b16 v[120:121], v16 offset:37120
    ds_read_b64_tr_b16 v[122:123], v17 offset:37120
    ds_read_b128 v[128:131], v23 offset:32768
    ds_read_b64_tr_b16 v[124:125], v16 offset:40960
    ds_read_b64_tr_b16 v[126:127], v17 offset:40960
    ds_read_b128 v[132:135], v24 offset:32768
    s_waitcnt lgkmcnt(12)
    v_mfma_f32_32x32x16_bf16 v[64:79], v[36:39], v[48:51], v[64:79]
    ds_read_b64_tr_b16 v[36:37], v16 offset:41216
    ds_read_b64_tr_b16 v[38:39], v17 offset:41216
    ds_read_b128 v[48:51], v25 offset:32768
    s_waitcnt lgkmcnt(12)
    v_mfma_f32_32x32x16_bf16 v[64:79], v[40:43], v[52:55], v[64:79]
    ds_read_b64_tr_b16 v[40:41], v16 offset:45056
    ds_read_b64_tr_b16 v[42:43], v17 offset:45056
    ds_read_b128 v[52:55], v26 offset:32768
    s_waitcnt lgkmcnt(12)
    v_mfma_f32_32x32x16_bf16 v[64:79], v[44:47], v[56:59], v[64:79]
    ds_read_b64_tr_b16 v[44:45], v16 offset:45312
    ds_read_b64_tr_b16 v[46:47], v17 offset:45312
    ds_read_b128 v[56:59], v27 offset:32768
    s_waitcnt lgkmcnt(12)
    v_mfma_f32_32x32x16_bf16 v[64:79], v[120:123], v[128:131], v[64:79]
    s_waitcnt lgkmcnt(9)
    v_mfma_f32_32x32x16_bf16 v[64:79], v[124:127], v[132:135], v[64:79]
    s_waitcnt lgkmcnt(6)
    v_mfma_f32_32x32x16_bf16 v[64:79], v[36:39], v[48:51], v[64:79]
    s_waitcnt lgkmcnt(3)
    v_mfma_f32_32x32x16_bf16 v[64:79], v[40:43], v[52:55], v[64:79]
    s_waitcnt lgkmcnt(0)
    v_mfma_f32_32x32x16_bf16 v[64:79], v[44:47], v[56:59], v[64:79]
    v_and_b32 v2, 31, v1
    v_lshrrev_b32 v3, 5, v1
    v_lshlrev_b32 v3, 3, v3
    v_sub_u32 v2, v2, v3
    v_lshlrev_b32 v3, 16, v156
    v_cmp_eq_u32 vcc, 0, v2
    s_nop 1
    v_cndmask_b32 v96, 0, v156, vcc
    v_cmp_eq_u32 vcc, 1, v2
    s_nop 1
    v_cndmask_b32 v96, v96, v3, vcc
    v_cmp_eq_u32 vcc, 2, v2
    s_nop 1
    v_cndmask_b32 v97, 0, v156, vcc
    v_cmp_eq_u32 vcc, 3, v2
    s_nop 1
    v_cndmask_b32 v97, v97, v3, vcc
    v_cmp_eq_u32 vcc, 4, v2
    s_nop 1
    v_cndmask_b32 v98, 0, v156, vcc
    v_cmp_eq_u32 vcc, 5, v2
    s_nop 1
    v_cndmask_b32 v98, v98, v3, vcc
    v_cmp_eq_u32 vcc, 6, v2
    s_nop 1
    v_cndmask_b32 v99, 0, v156, vcc
    v_cmp_eq_u32 vcc, 7, v2
    s_nop 1
    v_cndmask_b32 v99, v99, v3, vcc
    v_cmp_eq_u32 vcc, 16, v2
    s_nop 1
    v_cndmask_b32 v100, 0, v156, vcc
    v_cmp_eq_u32 vcc, 17, v2
    s_nop 1
    v_cndmask_b32 v100, v100, v3, vcc
    v_cmp_eq_u32 vcc, 18, v2
    s_nop 1
    v_cndmask_b32 v101, 0, v156, vcc
    v_cmp_eq_u32 vcc, 19, v2
    s_nop 1
    v_cndmask_b32 v101, v101, v3, vcc
    v_cmp_eq_u32 vcc, 20, v2
    s_nop 1
    v_cndmask_b32 v102, 0, v156, vcc
    v_cmp_eq_u32 vcc, 21, v2
    s_nop 1
    v_cndmask_b32 v102, v102, v3, vcc
    v_cmp_eq_u32 vcc, 22, v2
    s_nop 1
    v_cndmask_b32 v103, 0, v156, vcc
    v_cmp_eq_u32 vcc, 23, v2
    s_nop 1
    v_cndmask_b32 v103, v103, v3, vcc
    v_mfma_f32_32x32x16_bf16 v[64:79], v[148:151], v[96:99], v[64:79]
    s_nop 0
    v_mfma_f32_32x32x16_bf16 v[64:79], v[152:155], v[100:103], v[64:79]
    v_lshrrev_b32 v2, 5, v1
    v_lshlrev_b32 v2, 14, v2
    v_and_b32 v3, 31, v1
    v_lshl_add_u32 v2, v3, 2, v2
    s_lshl_b32 s7, s5, 19
    s_and_b32 s57, s6, 1
    s_lshl_b32 s57, s57, 18
    s_add_u32 s7, s7, s57
    s_and_b32 s57, s59, 1
    s_lshl_b32 s57, s57, 17
    s_add_u32 s7, s7, s57
    s_lshr_b32 s57, s6, 1
    s_lshl_b32 s57, s57, 8
    s_add_u32 s7, s7, s57
    s_lshr_b32 s57, s59, 1
    s_lshl_b32 s57, s57, 7
    s_add_u32 s7, s7, s57
    s_add_u32 s7, s7, 2048
    s_add_u32 s56, s7, 0
    buffer_store_dword v64, v2, s[20:23], s56 offen sc1
    s_add_u32 s56, s7, 4096
    buffer_store_dword v65, v2, s[20:23], s56 offen sc1
    s_add_u32 s56, s7, 8192
    buffer_store_dword v66, v2, s[20:23], s56 offen sc1
    s_add_u32 s56, s7, 12288
    buffer_store_dword v67, v2, s[20:23], s56 offen sc1
    s_add_u32 s56, s7, 32768
    buffer_store_dword v68, v2, s[20:23], s56 offen sc1
    s_add_u32 s56, s7, 36864
    buffer_store_dword v69, v2, s[20:23], s56 offen sc1
    s_add_u32 s56, s7, 40960
    buffer_store_dword v70, v2, s[20:23], s56 offen sc1
    s_add_u32 s56, s7, 45056
    buffer_store_dword v71, v2, s[20:23], s56 offen sc1
    s_add_u32 s56, s7, 65536
    buffer_store_dword v72, v2, s[20:23], s56 offen sc1
    s_add_u32 s56, s7, 69632
    buffer_store_dword v73, v2, s[20:23], s56 offen sc1
    s_add_u32 s56, s7, 73728
    buffer_store_dword v74, v2, s[20:23], s56 offen sc1
    s_add_u32 s56, s7, 77824
    buffer_store_dword v75, v2, s[20:23], s56 offen sc1
    s_add_u32 s56, s7, 98304
    buffer_store_dword v76, v2, s[20:23], s56 offen sc1
    s_add_u32 s56, s7, 102400
    buffer_store_dword v77, v2, s[20:23], s56 offen sc1
    s_add_u32 s56, s7, 106496
    buffer_store_dword v78, v2, s[20:23], s56 offen sc1
    s_add_u32 s56, s7, 110592
    buffer_store_dword v79, v2, s[20:23], s56 offen sc1
    s_barrier
    s_endpgm
Lcompute:
    s_load_dwordx2 s[20:21], s[0:1], 96
    s_mov_b32 s22, 0x800000
    s_mov_b32 s23, 0x00020000
    s_load_dwordx2 s[74:75], s[0:1], 104
    s_waitcnt lgkmcnt(0)
    s_cmp_lg_u32 s4, 2
    s_cbranch_scc1 Lnoloc_30
    s_getreg_b32 s7, hwreg(HW_REG_XCC_ID)
    s_and_b32 s7, s7, 7
    s_mul_i32 s7, s7, 5
    s_lshl_b32 s56, s5, 3
    s_add_u32 s56, s56, 128
    v_mov_b32 v145, s56
    s_lshl_b64 s[72:73], 1, s7
    s_or_b32 s73, s73, 0x100
    v_mov_b32 v146, s72
    v_mov_b32 v147, s73
    s_mov_b64 exec, 1
    global_atomic_add_x2 v145, v[146:147], s[74:75]
    s_mov_b64 exec, -1
Lnoloc_30:
    s_lshr_b32 s7, s4, 2
    s_lshl_b32 s7, s7, 13
    s_add_u32 s7, s7, 0
    v_lshlrev_b32 v2, 4, v1
    v_add_u32 v128, s7, v2
    v_and_b32 v2, 15, v1
    v_lshrrev_b32 v3, 5, v1
    v_lshlrev_b32 v3, 8, v3
    v_lshl_add_u32 v2, v2, 4, v3
    s_add_u32 s7, s7, 1024
    v_add_u32 v129, s7, v2
    s_mov_b32 s66, 0x0000ffff
    s_mov_b32 s67, 0x0000ffff
    v_and_b32 v2, 27, v1
    v_cmp_eq_u32 vcc, 16, v2
    v_mov_b32 v3, 0x3f803f80
    s_nop 0
    v_cndmask_b32 v112, 0, v3, vcc
    v_cndmask_b32 v113, 0, v3, vcc
    v_cndmask_b32 v114, 0, v3, vcc
    v_cndmask_b32 v115, 0, v3, vcc
    v_cndmask_b32 v116, 0, v3, vcc
    v_cndmask_b32 v117, 0, v3, vcc
    v_cndmask_b32 v118, 0, v3, vcc
    v_cndmask_b32 v119, 0, v3, vcc
    v_lshlrev_b32 v134, 4, v1
    v_add_u32 v135, 1024, v134
    s_lshl_b32 s62, s4, 11
    s_lshl_b32 s63, s5, 18
    s_add_u32 s63, s63, s62
    s_add_u32 s62, s62, 0
    s_lshl_b32 s8, s5, 4
    s_add_u32 s8, s8, s6
    s_lshl_b32 s8, s8, 3
    s_add_u32 s8, s8, s4
    s_lshl_b32 s8, s8, 2
    s_add_u32 s8, s8, 13697024
    v_and_b32 v2, 15, v1
    v_lshrrev_b32 v3, 2, v2
    v_and_b32 v2, 3, v2
    v_lshlrev_b32 v3, 6, v3
    v_lshl_add_u32 v3, v2, 3, v3
    v_bfe_u32 v2, v1, 4, 1
    v_lshl_add_u32 v3, v2, 5, v3
    v_lshrrev_b32 v2, 5, v1
    v_lshl_add_u32 v3, v2, 8, v3
    s_lshr_b32 s58, s4, 1
    s_lshl_b32 s7, s58, 13
    s_add_u32 s56, s7, 0
    v_add_u32 v137, s56, v3
    s_add_u32 s56, s7, 32768
    v_add_u32 v138, s56, v3
    s_lshl_b32 s9, s6, 2
    s_and_b32 s56, s5, 1
    s_lshl_b32 s56, s56, 1
    s_add_u32 s9, s9, s56
    s_and_b32 s56, s4, 1
    s_add_u32 s9, s9, s56
    s_lshl_b32 s9, s9, 15
    s_add_u32 s9, s9, s7
    s_add_u32 s9, s9, 6291456
    s_add_u32 s10, s9, 4096
    v_lshlrev_b32 v139, 4, v1
    v_lshrrev_b32 v3, 2, v1
    v_lshlrev_b32 v3, 10, v3
    v_and_b32 v144, 3, v1
    v_lshl_add_u32 v144, v144, 4, v3
    s_and_b32 s56, s4, 1
    s_cmp_eq_u32 s56, 0
    s_cselect_b32 s56, 65536, 0
    s_add_u32 s56, s56, 65536
    s_lshl_b32 s57, s58, 11
    s_add_u32 s57, s57, s56
    v_add_u32 v140, s57, v139
    s_add_u32 s57, s7, s56
    v_add_u32 v141, s57, v139
    v_lshrrev_b32 v2, 5, v1
    v_lshlrev_b32 v2, 14, v2
    v_and_b32 v3, 31, v1
    v_lshl_add_u32 v142, v3, 2, v2
    s_lshl_b32 s11, s6, 19
    s_and_b32 s57, s5, 1
    s_lshl_b32 s57, s57, 18
    s_add_u32 s11, s11, s57
    s_and_b32 s57, s4, 1
    s_lshl_b32 s57, s57, 17
    s_add_u32 s11, s11, s57
    s_and_b32 s57, s58, 1
    s_lshl_b32 s57, s57, 16
    s_add_u32 s11, s11, s57
    s_lshr_b32 s57, s5, 1
    s_lshl_b32 s57, s57, 8
    s_add_u32 s11, s11, s57
    s_lshr_b32 s57, s58, 1
    s_lshl_b32 s57, s57, 7
    s_add_u32 s11, s11, s57
    v_and_b32 v2, 31, v1
    v_lshrrev_b32 v3, 1, v2
    v_and_b32 v3, 7, v3
    v_lshrrev_b32 v4, 5, v1
    v_xor_b32 v3, v3, v4
    s_and_b32 s7, s4, 3
    s_lshl_b32 s7, s7, 12
    s_add_u32 s7, s7, 98304
    v_lshlrev_b32 v2, 7, v2
    v_add_u32 v2, s7, v2
    v_xor_b32 v4, 0, v3
    v_lshl_add_u32 v5, v4, 4, v2
    v_xor_b32 v4, 2, v3
    v_lshl_add_u32 v6, v4, 4, v2
    v_xor_b32 v4, 4, v3
    v_lshl_add_u32 v7, v4, 4, v2
    v_xor_b32 v4, 6, v3
    v_lshl_add_u32 v8, v4, 4, v2
    v_and_b32 v2, 15, v1
    v_lshrrev_b32 v3, 2, v2
    v_and_b32 v2, 3, v2
    v_lshrrev_b32 v4, 5, v1
    v_lshl_add_u32 v3, v4, 3, v3
    v_lshlrev_b32 v3, 6, v3
    v_lshl_add_u32 v3, v2, 3, v3
    v_bfe_u32 v4, v1, 4, 1
    v_lshl_add_u32 v10, v4, 5, v3
    v_add_u32 v10, 65536, v10
    s_lshr_b32 s7, s4, 2
    v_xor_b32 v2, s7, v4
    v_lshl_add_u32 v3, v2, 5, v3
    v_lshl_add_u32 v9, v4, 15, v3
    v_mov_b32 v121, 0
    s_mov_b32 s7, 13631488
    buffer_load_dword v120, v121, s[16:19], s7 offen sc1
    s_cmp_ge_u32 s4, 4
    s_cbranch_scc1 Lqkv_hd1_31
    s_barrier
    ds_read_b128 v[48:51], v5 offset:0
    ds_read_b64_tr_b16 v[64:65], v9 offset:0
    ds_read_b64_tr_b16 v[66:67], v9 offset:256
    ds_read_b64_tr_b16 v[80:81], v10 offset:0
    ds_read_b64_tr_b16 v[82:83], v10 offset:256
    ds_read_b128 v[52:55], v6 offset:0
    ds_read_b64_tr_b16 v[68:69], v9 offset:1024
    ds_read_b64_tr_b16 v[70:71], v9 offset:1280
    ds_read_b64_tr_b16 v[84:85], v10 offset:1024
    ds_read_b64_tr_b16 v[86:87], v10 offset:1280
    ds_read_b128 v[56:59], v7 offset:0
    ds_read_b64_tr_b16 v[72:73], v9 offset:2048
    ds_read_b64_tr_b16 v[74:75], v9 offset:2304
    ds_read_b64_tr_b16 v[88:89], v10 offset:2048
    ds_read_b64_tr_b16 v[90:91], v10 offset:2304
    s_waitcnt lgkmcnt(12)
    v_mfma_f32_32x32x16_bf16 v[16:31], v[64:67], v[48:51], 0
    s_waitcnt lgkmcnt(10)
    v_mfma_f32_32x32x16_bf16 v[32:47], v[48:51], v[80:83], 0
    ds_read_b128 v[60:63], v8 offset:0
    ds_read_b64_tr_b16 v[76:77], v9 offset:3072
    ds_read_b64_tr_b16 v[78:79], v9 offset:3328
    ds_read_b64_tr_b16 v[92:93], v10 offset:3072
    ds_read_b64_tr_b16 v[94:95], v10 offset:3328
    s_waitcnt lgkmcnt(12)
    v_mfma_f32_32x32x16_bf16 v[16:31], v[68:71], v[52:55], v[16:31]
    s_waitcnt lgkmcnt(10)
    v_mfma_f32_32x32x16_bf16 v[32:47], v[52:55], v[84:87], v[32:47]
    s_barrier
    ds_read_b128 v[48:51], v5 offset:16384
    ds_read_b64_tr_b16 v[64:65], v9 offset:4096
    ds_read_b64_tr_b16 v[66:67], v9 offset:4352
    ds_read_b64_tr_b16 v[80:81], v10 offset:4096
    ds_read_b64_tr_b16 v[82:83], v10 offset:4352
    ds_read_b128 v[52:55], v6 offset:16384
    ds_read_b64_tr_b16 v[68:69], v9 offset:5120
    ds_read_b64_tr_b16 v[70:71], v9 offset:5376
    ds_read_b64_tr_b16 v[84:85], v10 offset:5120
    ds_read_b64_tr_b16 v[86:87], v10 offset:5376
    s_waitcnt lgkmcnt(15)
    v_mfma_f32_32x32x16_bf16 v[16:31], v[72:75], v[56:59], v[16:31]
    v_mfma_f32_32x32x16_bf16 v[32:47], v[56:59], v[88:91], v[32:47]
    s_waitcnt lgkmcnt(12)
    v_mfma_f32_32x32x16_bf16 v[16:31], v[76:79], v[60:63], v[16:31]
    s_waitcnt lgkmcnt(10)
    v_mfma_f32_32x32x16_bf16 v[32:47], v[60:63], v[92:95], v[32:47]
    ds_read_b128 v[56:59], v7 offset:16384
    ds_read_b64_tr_b16 v[72:73], v9 offset:6144
    ds_read_b64_tr_b16 v[74:75], v9 offset:6400
    ds_read_b64_tr_b16 v[88:89], v10 offset:6144
    ds_read_b64_tr_b16 v[90:91], v10 offset:6400
    s_waitcnt lgkmcnt(12)
    v_mfma_f32_32x32x16_bf16 v[16:31], v[64:67], v[48:51], v[16:31]
    s_waitcnt lgkmcnt(10)
    v_mfma_f32_32x32x16_bf16 v[32:47], v[48:51], v[80:83], v[32:47]
    ds_read_b128 v[60:63], v8 offset:16384
    ds_read_b64_tr_b16 v[76:77], v9 offset:7168
    ds_read_b64_tr_b16 v[78:79], v9 offset:7424
    ds_read_b64_tr_b16 v[92:93], v10 offset:7168
    ds_read_b64_tr_b16 v[94:95], v10 offset:7424
    s_waitcnt lgkmcnt(12)
    v_mfma_f32_32x32x16_bf16 v[16:31], v[68:71], v[52:55], v[16:31]
    s_waitcnt lgkmcnt(10)
    v_mfma_f32_32x32x16_bf16 v[32:47], v[52:55], v[84:87], v[32:47]
    s_barrier
    s_waitcnt vmcnt(0)
    v_readfirstlane_b32 s69, v120
    s_nop 3
    s_add_u32 s69, s69, 0x61c88647
    ds_read_b128 v[48:51], v5 offset:32768
    ds_read_b64_tr_b16 v[64:65], v9 offset:8192
    ds_read_b64_tr_b16 v[66:67], v9 offset:8448
    ds_read_b64_tr_b16 v[80:81], v10 offset:8192
    ds_read_b64_tr_b16 v[82:83], v10 offset:8448
    ds_read_b128 v[52:55], v6 offset:32768
    ds_read_b64_tr_b16 v[68:69], v9 offset:9216
    ds_read_b64_tr_b16 v[70:71], v9 offset:9472
    ds_read_b64_tr_b16 v[84:85], v10 offset:9216
    ds_read_b64_tr_b16 v[86:87], v10 offset:9472
    s_waitcnt lgkmcnt(15)
    v_mfma_f32_32x32x16_bf16 v[16:31], v[72:75], v[56:59], v[16:31]
    v_mfma_f32_32x32x16_bf16 v[32:47], v[56:59], v[88:91], v[32:47]
    s_waitcnt lgkmcnt(12)
    v_mfma_f32_32x32x16_bf16 v[16:31], v[76:79], v[60:63], v[16:31]
    s_waitcnt lgkmcnt(10)
    v_mfma_f32_32x32x16_bf16 v[32:47], v[60:63], v[92:95], v[32:47]
    ds_read_b128 v[56:59], v7 offset:32768
    ds_read_b64_tr_b16 v[72:73], v9 offset:10240
    ds_read_b64_tr_b16 v[74:75], v9 offset:10496
    ds_read_b64_tr_b16 v[88:89], v10 offset:10240
    ds_read_b64_tr_b16 v[90:91], v10 offset:10496
    s_waitcnt lgkmcnt(12)
    v_mfma_f32_32x32x16_bf16 v[16:31], v[64:67], v[48:51], v[16:31]
    s_waitcnt lgkmcnt(10)
    v_mfma_f32_32x32x16_bf16 v[32:47], v[48:51], v[80:83], v[32:47]
    ds_read_b128 v[60:63], v8 offset:32768
    ds_read_b64_tr_b16 v[76:77], v9 offset:11264
    ds_read_b64_tr_b16 v[78:79], v9 offset:11520
    ds_read_b64_tr_b16 v[92:93], v10 offset:11264
    ds_read_b64_tr_b16 v[94:95], v10 offset:11520
    s_waitcnt lgkmcnt(12)
    v_mfma_f32_32x32x16_bf16 v[16:31], v[68:71], v[52:55], v[16:31]
    s_waitcnt lgkmcnt(10)
    v_mfma_f32_32x32x16_bf16 v[32:47], v[52:55], v[84:87], v[32:47]
    s_barrier
    s_cmp_lg_u32 s4, 2
    s_cbranch_scc1 Lnoloc_34
    s_getreg_b32 s7, hwreg(HW_REG_XCC_ID)
    s_and_b32 s7, s7, 7
    s_mul_i32 s7, s7, 5
    s_lshl_b32 s56, s5, 3
    s_add_u32 s56, s56, 128
    v_mov_b32 v145, s56
    global_load_dwordx2 v[146:147], v145, s[74:75] sc1
Lnoloc_34:
    ds_read_b128 v[48:51], v5 offset:49152
    ds_read_b64_tr_b16 v[64:65], v9 offset:12288
    ds_read_b64_tr_b16 v[66:67], v9 offset:12544
    ds_read_b64_tr_b16 v[80:81], v10 offset:12288
    ds_read_b64_tr_b16 v[82:83], v10 offset:12544
    ds_read_b128 v[52:55], v6 offset:49152
    ds_read_b64_tr_b16 v[68:69], v9 offset:13312
    ds_read_b64_tr_b16 v[70:71], v9 offset:13568
    ds_read_b64_tr_b16 v[84:85], v10 offset:13312
    ds_read_b64_tr_b16 v[86:87], v10 offset:13568
    s_waitcnt lgkmcnt(15)
    v_mfma_f32_32x32x16_bf16 v[16:31], v[72:75], v[56:59], v[16:31]
    v_mfma_f32_32x32x16_bf16 v[32:47], v[56:59], v[88:91], v[32:47]
    s_waitcnt lgkmcnt(12)
    v_mfma_f32_32x32x16_bf16 v[16:31], v[76:79], v[60:63], v[16:31]
    s_waitcnt lgkmcnt(10)
    v_mfma_f32_32x32x16_bf16 v[32:47], v[60:63], v[92:95], v[32:47]
    ds_read_b128 v[56:59], v7 offset:49152
    ds_read_b64_tr_b16 v[72:73], v9 offset:14336
    ds_read_b64_tr_b16 v[74:75], v9 offset:14592
    ds_read_b64_tr_b16 v[88:89], v10 offset:14336
    ds_read_b64_tr_b16 v[90:91], v10 offset:14592
    s_waitcnt lgkmcnt(12)
    v_mfma_f32_32x32x16_bf16 v[16:31], v[64:67], v[48:51], v[16:31]
    s_waitcnt lgkmcnt(10)
    v_mfma_f32_32x32x16_bf16 v[32:47], v[48:51], v[80:83], v[32:47]
    ds_read_b128 v[60:63], v8 offset:49152
    ds_read_b64_tr_b16 v[76:77], v9 offset:15360
    ds_read_b64_tr_b16 v[78:79], v9 offset:15616
    ds_read_b64_tr_b16 v[92:93], v10 offset:15360
    ds_read_b64_tr_b16 v[94:95], v10 offset:15616
    s_waitcnt lgkmcnt(12)
    v_mfma_f32_32x32x16_bf16 v[16:31], v[68:71], v[52:55], v[16:31]
    s_waitcnt lgkmcnt(10)
    v_mfma_f32_32x32x16_bf16 v[32:47], v[52:55], v[84:87], v[32:47]
    s_barrier
    s_cmp_ge_u32 s4, 2
    s_cbranch_scc1 Lnotouch_35
    s_lshl_b32 s7, s68, 14
    s_lshl_b32 s56, s4, 13
    s_add_u32 s7, s7, s56
    v_lshlrev_b32 v136, 7, v1
    buffer_load_dword v126, v136, s[16:19], s7 offen
Lnotouch_35:
    ds_read_b128 v[48:51], v5 offset:0
    ds_read_b64_tr_b16 v[64:65], v9 offset:16384
    ds_read_b64_tr_b16 v[66:67], v9 offset:16640
    ds_read_b64_tr_b16 v[80:81], v10 offset:16384
    ds_read_b64_tr_b16 v[82:83], v10 offset:16640
    ds_read_b128 v[52:55], v6 offset:0
    ds_read_b64_tr_b16 v[68:69], v9 offset:17408
    ds_read_b64_tr_b16 v[70:71], v9 offset:17664
    ds_read_b64_tr_b16 v[84:85], v10 offset:17408
    ds_read_b64_tr_b16 v[86:87], v10 offset:17664
    s_waitcnt lgkmcnt(15)
    v_mfma_f32_32x32x16_bf16 v[16:31], v[72:75], v[56:59], v[16:31]
    v_mfma_f32_32x32x16_bf16 v[32:47], v[56:59], v[88:91], v[32:47]
    s_waitcnt lgkmcnt(12)
    v_mfma_f32_32x32x16_bf16 v[16:31], v[76:79], v[60:63], v[16:31]
    s_waitcnt lgkmcnt(10)
    v_mfma_f32_32x32x16_bf16 v[32:47], v[60:63], v[92:95], v[32:47]
    ds_read_b128 v[56:59], v7 offset:0
    ds_read_b64_tr_b16 v[72:73], v9 offset:18432
    ds_read_b64_tr_b16 v[74:75], v9 offset:18688
    ds_read_b64_tr_b16 v[88:89], v10 offset:18432
    ds_read_b64_tr_b16 v[90:91], v10 offset:18688
    s_waitcnt lgkmcnt(12)
    v_mfma_f32_32x32x16_bf16 v[16:31], v[64:67], v[48:51], v[16:31]
    s_waitcnt lgkmcnt(10)
    v_mfma_f32_32x32x16_bf16 v[32:47], v[48:51], v[80:83], v[32:47]
    ds_read_b128 v[60:63], v8 offset:0
    ds_read_b64_tr_b16 v[76:77], v9 offset:19456
    ds_read_b64_tr_b16 v[78:79], v9 offset:19712
    ds_read_b64_tr_b16 v[92:93], v10 offset:19456
    ds_read_b64_tr_b16 v[94:95], v10 offset:19712
    s_waitcnt lgkmcnt(12)
    v_mfma_f32_32x32x16_bf16 v[16:31], v[68:71], v[52:55], v[16:31]
    s_waitcnt lgkmcnt(10)
    v_mfma_f32_32x32x16_bf16 v[32:47], v[52:55], v[84:87], v[32:47]
    s_barrier
    ds_read_b128 v[48:51], v5 offset:16384
    ds_read_b64_tr_b16 v[64:65], v9 offset:20480
    ds_read_b64_tr_b16 v[66:67], v9 offset:20736
    ds_read_b64_tr_b16 v[80:81], v10 offset:20480
    ds_read_b64_tr_b16 v[82:83], v10 offset:20736
    ds_read_b128 v[52:55], v6 offset:16384
    ds_read_b64_tr_b16 v[68:69], v9 offset:21504
    ds_read_b64_tr_b16 v[70:71], v9 offset:21760
    ds_read_b64_tr_b16 v[84:85], v10 offset:21504
    ds_read_b64_tr_b16 v[86:87], v10 offset:21760
    s_waitcnt lgkmcnt(15)
    v_mfma_f32_32x32x16_bf16 v[16:31], v[72:75], v[56:59], v[16:31]
    v_mfma_f32_32x32x16_bf16 v[32:47], v[56:59], v[88:91], v[32:47]
    s_waitcnt lgkmcnt(12)
    v_mfma_f32_32x32x16_bf16 v[16:31], v[76:79], v[60:63], v[16:31]
    s_waitcnt lgkmcnt(10)
    v_mfma_f32_32x32x16_bf16 v[32:47], v[60:63], v[92:95], v[32:47]
    ds_read_b128 v[56:59], v7 offset:16384
    ds_read_b64_tr_b16 v[72:73], v9 offset:22528
    ds_read_b64_tr_b16 v[74:75], v9 offset:22784
    ds_read_b64_tr_b16 v[88:89], v10 offset:22528
    ds_read_b64_tr_b16 v[90:91], v10 offset:22784
    s_waitcnt lgkmcnt(12)
    v_mfma_f32_32x32x16_bf16 v[16:31], v[64:67], v[48:51], v[16:31]
    s_waitcnt lgkmcnt(10)
    v_mfma_f32_32x32x16_bf16 v[32:47], v[48:51], v[80:83], v[32:47]
    ds_read_b128 v[60:63], v8 offset:16384
    ds_read_b64_tr_b16 v[76:77], v9 offset:23552
    ds_read_b64_tr_b16 v[78:79], v9 offset:23808
    ds_read_b64_tr_b16 v[92:93], v10 offset:23552
    ds_read_b64_tr_b16 v[94:95], v10 offset:23808
    s_waitcnt lgkmcnt(12)
    v_mfma_f32_32x32x16_bf16 v[16:31], v[68:71], v[52:55], v[16:31]
    s_waitcnt lgkmcnt(10)
    v_mfma_f32_32x32x16_bf16 v[32:47], v[52:55], v[84:87], v[32:47]
    s_barrier
    s_cmp_lg_u32 s4, 2
    s_cbranch_scc1 Lnoloc_36
    s_getreg_b32 s7, hwreg(HW_REG_XCC_ID)
    s_and_b32 s7, s7, 7
    s_mul_i32 s7, s7, 5
    s_lshl_b32 s56, s5, 3
    s_add_u32 s56, s56, 128
    v_mov_b32 v145, s56
    s_mov_b32 s71, 40000
    s_branch Llocf_39
Lloc_37:
    global_load_dwordx2 v[146:147], v145, s[74:75] sc1
Llocf_39:
    s_waitcnt vmcnt(0)
    v_readfirstlane_b32 s72, v146
    v_readfirstlane_b32 s73, v147
    s_nop 3
    s_lshr_b32 s56, s73, 8
    s_cmp_ge_u32 s56, 16
    s_cbranch_scc1 Llocd_38
    s_sub_u32 s71, s71, 1
    s_cmp_eq_u32 s71, 0
    s_cbranch_scc1 Llocd_38
    s_sleep 4
    s_branch Lloc_37
Llocd_38:
    s_lshr_b64 s[72:73], s[72:73], s7
    s_and_b32 s72, s72, 31
    s_cmp_eq_u32 s72, 16
    s_cselect_b32 s3, 1, 0
    s_cmp_eq_u32 s56, 16
    s_cselect_b32 s3, s3, 0
    v_mov_b32 v146, s3
    v_mov_b32 v145, 0
    ds_write_b32 v145, v146
    s_waitcnt lgkmcnt(0)
Lnoloc_36:
    ds_read_b128 v[48:51], v5 offset:32768
    ds_read_b64_tr_b16 v[64:65], v9 offset:24576
    ds_read_b64_tr_b16 v[66:67], v9 offset:24832
    ds_read_b64_tr_b16 v[80:81], v10 offset:24576
    ds_read_b64_tr_b16 v[82:83], v10 offset:24832
    ds_read_b128 v[52:55], v6 offset:32768
    ds_read_b64_tr_b16 v[68:69], v9 offset:25600
    ds_read_b64_tr_b16 v[70:71], v9 offset:25856
    ds_read_b64_tr_b16 v[84:85], v10 offset:25600
    ds_read_b64_tr_b16 v[86:87], v10 offset:25856
    s_waitcnt lgkmcnt(15)
    v_mfma_f32_32x32x16_bf16 v[16:31], v[72:75], v[56:59], v[16:31]
    v_mfma_f32_32x32x16_bf16 v[32:47], v[56:59], v[88:91], v[32:47]
    s_waitcnt lgkmcnt(12)
    v_mfma_f32_32x32x16_bf16 v[16:31], v[76:79], v[60:63], v[16:31]
    s_waitcnt lgkmcnt(10)
    v_mfma_f32_32x32x16_bf16 v[32:47], v[60:63], v[92:95], v[32:47]
    ds_read_b128 v[56:59], v7 offset:32768
    ds_read_b64_tr_b16 v[72:73], v9 offset:26624
    ds_read_b64_tr_b16 v[74:75], v9 offset:26880
    ds_read_b64_tr_b16 v[88:89], v10 offset:26624
    ds_read_b64_tr_b16 v[90:91], v10 offset:26880
    s_waitcnt lgkmcnt(12)
    v_mfma_f32_32x32x16_bf16 v[16:31], v[64:67], v[48:51], v[16:31]
    s_waitcnt lgkmcnt(10)
    v_mfma_f32_32x32x16_bf16 v[32:47], v[48:51], v[80:83], v[32:47]
    ds_read_b128 v[60:63], v8 offset:32768
    ds_read_b64_tr_b16 v[76:77], v9 offset:27648
    ds_read_b64_tr_b16 v[78:79], v9 offset:27904
    ds_read_b64_tr_b16 v[92:93], v10 offset:27648
    ds_read_b64_tr_b16 v[94:95], v10 offset:27904
    s_waitcnt lgkmcnt(12)
    v_mfma_f32_32x32x16_bf16 v[16:31], v[68:71], v[52:55], v[16:31]
    s_waitcnt lgkmcnt(10)
    v_mfma_f32_32x32x16_bf16 v[32:47], v[52:55], v[84:87], v[32:47]
    s_barrier
    v_mov_b32 v136, 0
    ds_read_b32 v122, v136
    ds_read_b128 v[48:51], v5 offset:49152
    ds_read_b64_tr_b16 v[64:65], v9 offset:28672
    ds_read_b64_tr_b16 v[66:67], v9 offset:28928
    ds_read_b64_tr_b16 v[80:81], v10 offset:28672
    ds_read_b64_tr_b16 v[82:83], v10 offset:28928
    ds_read_b128 v[52:55], v6 offset:49152
    ds_read_b64_tr_b16 v[68:69], v9 offset:29696
    ds_read_b64_tr_b16 v[70:71], v9 offset:29952
    ds_read_b64_tr_b16 v[84:85], v10 offset:29696
    ds_read_b64_tr_b16 v[86:87], v10 offset:29952
    s_waitcnt lgkmcnt(15)
    v_mfma_f32_32x32x16_bf16 v[16:31], v[72:75], v[56:59], v[16:31]
    v_mfma_f32_32x32x16_bf16 v[32:47], v[56:59], v[88:91], v[32:47]
    s_waitcnt lgkmcnt(13)
    v_mfma_f32_32x32x16_bf16 v[16:31], v[76:79], v[60:63], v[16:31]
    s_waitcnt lgkmcnt(11)
    v_mfma_f32_32x32x16_bf16 v[32:47], v[60:63], v[92:95], v[32:47]
    ds_read_b128 v[56:59], v7 offset:49152
    ds_read_b64_tr_b16 v[72:73], v9 offset:30720
    ds_read_b64_tr_b16 v[74:75], v9 offset:30976
    ds_read_b64_tr_b16 v[88:89], v10 offset:30720
    ds_read_b64_tr_b16 v[90:91], v10 offset:30976
    s_waitcnt lgkmcnt(12)
    v_mfma_f32_32x32x16_bf16 v[16:31], v[64:67], v[48:51], v[16:31]
    s_waitcnt lgkmcnt(10)
    v_mfma_f32_32x32x16_bf16 v[32:47], v[48:51], v[80:83], v[32:47]
    ds_read_b128 v[60:63], v8 offset:49152
    ds_read_b64_tr_b16 v[76:77], v9 offset:31744
    ds_read_b64_tr_b16 v[78:79], v9 offset:32000
    ds_read_b64_tr_b16 v[92:93], v10 offset:31744
    ds_read_b64_tr_b16 v[94:95], v10 offset:32000
    s_waitcnt lgkmcnt(12)
    v_mfma_f32_32x32x16_bf16 v[16:31], v[68:71], v[52:55], v[16:31]
    s_waitcnt lgkmcnt(10)
    v_mfma_f32_32x32x16_bf16 v[32:47], v[52:55], v[84:87], v[32:47]
    v_readfirstlane_b32 s3, v122
    s_waitcnt lgkmcnt(7)
    v_mfma_f32_32x32x16_bf16 v[16:31], v[72:75], v[56:59], v[16:31]
    s_waitcnt lgkmcnt(5)
    v_mfma_f32_32x32x16_bf16 v[32:47], v[56:59], v[88:91], v[32:47]
    s_waitcnt lgkmcnt(2)
    v_mfma_f32_32x32x16_bf16 v[16:31], v[76:79], v[60:63], v[16:31]
    s_waitcnt lgkmcnt(0)
    v_mfma_f32_32x32x16_bf16 v[32:47], v[60:63], v[92:95], v[32:47]
    s_barrier
    s_lshl_b32 s56, s68, 14
    s_lshr_b32 s7, s4, 2
    s_lshl_b32 s58, s7, 13
    s_and_b32 s7, s4, 3
    s_lshl_b32 s7, s7, 11
    s_add_u32 s58, s58, s7
    s_add_u32 s57, s56, s58
    s_add_u32 s56, s56, s7
    v_lshlrev_b32 v2, 4, v1
    v_add_u32 v3, s58, v2
    v_bfe_u32 v5, v1, 4, 1
    v_lshlrev_b32 v5, 13, v5
    v_and_b32 v4, 15, v1
    v_lshl_add_u32 v5, v4, 4, v5
    v_lshrrev_b32 v4, 5, v1
    v_lshl_add_u32 v5, v4, 8, v5
    v_add_u32 v6, s7, v5
    v_cvt_pk_bf16_f32 v100, v24, v25
    v_cvt_pk_bf16_f32 v101, v26, v27
    v_cvt_pk_bf16_f32 v102, v28, v29
    v_cvt_pk_bf16_f32 v103, v30, v31
    v_cvt_pk_bf16_f32 v104, v32, v33
    v_cvt_pk_bf16_f32 v105, v34, v35
    v_cvt_pk_bf16_f32 v106, v36, v37
    v_cvt_pk_bf16_f32 v107, v38, v39
    v_cvt_pk_bf16_f32 v108, v40, v41
    v_cvt_pk_bf16_f32 v109, v42, v43
    v_cvt_pk_bf16_f32 v110, v44, v45
    v_cvt_pk_bf16_f32 v111, v46, v47
    s_cmp_eq_u32 s3, 0
    s_cbranch_scc1 Lfar_40
    buffer_store_dwordx4 v[100:103], v2, s[16:19], s57 offen
    buffer_store_dwordx4 v[104:107], v5, s[16:19], s56 offen offset:1024
    buffer_store_dwordx4 v[108:111], v5, s[16:19], s56 offen offset:1536
    s_branch Ljoin_41
Lfar_40:
    buffer_store_dwordx4 v[100:103], v2, s[16:19], s57 offen sc1
    buffer_store_dwordx4 v[104:107], v5, s[16:19], s56 offen offset:1024 sc1
    buffer_store_dwordx4 v[108:111], v5, s[16:19], s56 offen offset:1536 sc1
Ljoin_41:
    ds_write_b128 v3, v[100:103] offset:0
    ds_write_b128 v6, v[104:107] offset:1024
    ds_write_b128 v6, v[108:111] offset:1536
    s_mov_b32 s7, 0x3eb8aa3b
    v_mul_f32 v16, s7, v16
    v_mul_f32 v17, s7, v17
    v_mul_f32 v18, s7, v18
    v_mul_f32 v19, s7, v19
    v_mul_f32 v20, s7, v20
    v_mul_f32 v21, s7, v21
    v_mul_f32 v22, s7, v22
    v_mul_f32 v23, s7, v23
    v_cvt_pk_bf16_f32 v96, v16, v17
    v_cvt_pk_bf16_f32 v97, v18, v19
    v_cvt_pk_bf16_f32 v98, v20, v21
    v_cvt_pk_bf16_f32 v99, v22, v23
    s_branch Lqkv_join_32
Lqkv_hd1_31:
    s_barrier
    ds_read_b128 v[48:51], v5 offset:0
    ds_read_b64_tr_b16 v[64:65], v9 offset:0
    ds_read_b64_tr_b16 v[66:67], v9 offset:256
    ds_read_b128 v[52:55], v6 offset:0
    ds_read_b64_tr_b16 v[68:69], v9 offset:1024
    ds_read_b64_tr_b16 v[70:71], v9 offset:1280
    ds_read_b128 v[56:59], v7 offset:0
    ds_read_b64_tr_b16 v[72:73], v9 offset:2048
    ds_read_b64_tr_b16 v[74:75], v9 offset:2304
    s_waitcnt lgkmcnt(6)
    v_mfma_f32_32x32x16_bf16 v[16:31], v[64:67], v[48:51], 0
    ds_read_b128 v[60:63], v8 offset:0
    ds_read_b64_tr_b16 v[76:77], v9 offset:3072
    ds_read_b64_tr_b16 v[78:79], v9 offset:3328
    s_waitcnt lgkmcnt(6)
    v_mfma_f32_32x32x16_bf16 v[16:31], v[68:71], v[52:55], v[16:31]
    s_barrier
    ds_read_b128 v[48:51], v5 offset:16384
    ds_read_b64_tr_b16 v[64:65], v9 offset:4096
    ds_read_b64_tr_b16 v[66:67], v9 offset:4352
    ds_read_b128 v[52:55], v6 offset:16384
    ds_read_b64_tr_b16 v[68:69], v9 offset:5120
    ds_read_b64_tr_b16 v[70:71], v9 offset:5376
    s_waitcnt lgkmcnt(9)
    v_mfma_f32_32x32x16_bf16 v[16:31], v[72:75], v[56:59], v[16:31]
    s_waitcnt lgkmcnt(6)
    v_mfma_f32_32x32x16_bf16 v[16:31], v[76:79], v[60:63], v[16:31]
    ds_read_b128 v[56:59], v7 offset:16384
    ds_read_b64_tr_b16 v[72:73], v9 offset:6144
    ds_read_b64_tr_b16 v[74:75], v9 offset:6400
    s_waitcnt lgkmcnt(6)
    v_mfma_f32_32x32x16_bf16 v[16:31], v[64:67], v[48:51], v[16:31]
    ds_read_b128 v[60:63], v8 offset:16384
    ds_read_b64_tr_b16 v[76:77], v9 offset:7168
    ds_read_b64_tr_b16 v[78:79], v9 offset:7424
    s_waitcnt lgkmcnt(6)
    v_mfma_f32_32x32x16_bf16 v[16:31], v[68:71], v[52:55], v[16:31]
    s_barrier
    s_waitcnt vmcnt(0)
    v_readfirstlane_b32 s69, v120
    s_nop 3
    s_add_u32 s69, s69, 0x61c88647
    ds_read_b128 v[48:51], v5 offset:32768
    ds_read_b64_tr_b16 v[64:65], v9 offset:8192
    ds_read_b64_tr_b16 v[66:67], v9 offset:8448
    ds_read_b128 v[52:55], v6 offset:32768
    ds_read_b64_tr_b16 v[68:69], v9 offset:9216
    ds_read_b64_tr_b16 v[70:71], v9 offset:9472
    s_waitcnt lgkmcnt(9)
    v_mfma_f32_32x32x16_bf16 v[16:31], v[72:75], v[56:59], v[16:31]
    s_waitcnt lgkmcnt(6)
    v_mfma_f32_32x32x16_bf16 v[16:31], v[76:79], v[60:63], v[16:31]
    ds_read_b128 v[56:59], v7 offset:32768
    ds_read_b64_tr_b16 v[72:73], v9 offset:10240
    ds_read_b64_tr_b16 v[74:75], v9 offset:10496
    s_waitcnt lgkmcnt(6)
    v_mfma_f32_32x32x16_bf16 v[16:31], v[64:67], v[48:51], v[16:31]
    ds_read_b128 v[60:63], v8 offset:32768
    ds_read_b64_tr_b16 v[76:77], v9 offset:11264
    ds_read_b64_tr_b16 v[78:79], v9 offset:11520
    s_waitcnt lgkmcnt(6)
    v_mfma_f32_32x32x16_bf16 v[16:31], v[68:71], v[52:55], v[16:31]
    s_barrier
    ds_read_b128 v[48:51], v5 offset:49152
    ds_read_b64_tr_b16 v[64:65], v9 offset:12288
    ds_read_b64_tr_b16 v[66:67], v9 offset:12544
    ds_read_b128 v[52:55], v6 offset:49152
    ds_read_b64_tr_b16 v[68:69], v9 offset:13312
    ds_read_b64_tr_b16 v[70:71], v9 offset:13568
    s_waitcnt lgkmcnt(9)
    v_mfma_f32_32x32x16_bf16 v[16:31], v[72:75], v[56:59], v[16:31]
    s_waitcnt lgkmcnt(6)
    v_mfma_f32_32x32x16_bf16 v[16:31], v[76:79], v[60:63], v[16:31]
    ds_read_b128 v[56:59], v7 offset:49152
    ds_read_b64_tr_b16 v[72:73], v9 offset:14336
    ds_read_b64_tr_b16 v[74:75], v9 offset:14592
    s_waitcnt lgkmcnt(6)
    v_mfma_f32_32x32x16_bf16 v[16:31], v[64:67], v[48:51], v[16:31]
    ds_read_b128 v[60:63], v8 offset:49152
    ds_read_b64_tr_b16 v[76:77], v9 offset:15360
    ds_read_b64_tr_b16 v[78:79], v9 offset:15616
    s_waitcnt lgkmcnt(6)
    v_mfma_f32_32x32x16_bf16 v[16:31], v[68:71], v[52:55], v[16:31]
    s_barrier
    ds_read_b128 v[48:51], v5 offset:0
    ds_read_b64_tr_b16 v[64:65], v9 offset:16384
    ds_read_b64_tr_b16 v[66:67], v9 offset:16640
    ds_read_b128 v[52:55], v6 offset:0
    ds_read_b64_tr_b16 v[68:69], v9 offset:17408
    ds_read_b64_tr_b16 v[70:71], v9 offset:17664
    s_waitcnt lgkmcnt(9)
    v_mfma_f32_32x32x16_bf16 v[16:31], v[72:75], v[56:59], v[16:31]
    s_waitcnt lgkmcnt(6)
    v_mfma_f32_32x32x16_bf16 v[16:31], v[76:79], v[60:63], v[16:31]
    ds_read_b128 v[56:59], v7 offset:0
    ds_read_b64_tr_b16 v[72:73], v9 offset:18432
    ds_read_b64_tr_b16 v[74:75], v9 offset:18688
    s_waitcnt lgkmcnt(6)
    v_mfma_f32_32x32x16_bf16 v[16:31], v[64:67], v[48:51], v[16:31]
    ds_read_b128 v[60:63], v8 offset:0
    ds_read_b64_tr_b16 v[76:77], v9 offset:19456
    ds_read_b64_tr_b16 v[78:79], v9 offset:19712
    s_waitcnt lgkmcnt(6)
    v_mfma_f32_32x32x16_bf16 v[16:31], v[68:71], v[52:55], v[16:31]
    s_barrier
    ds_read_b128 v[48:51], v5 offset:16384
    ds_read_b64_tr_b16 v[64:65], v9 offset:20480
    ds_read_b64_tr_b16 v[66:67], v9 offset:20736
    ds_read_b128 v[52:55], v6 offset:16384
    ds_read_b64_tr_b16 v[68:69], v9 offset:21504
    ds_read_b64_tr_b16 v[70:71], v9 offset:21760
    s_waitcnt lgkmcnt(9)
    v_mfma_f32_32x32x16_bf16 v[16:31], v[72:75], v[56:59], v[16:31]
    s_waitcnt lgkmcnt(6)
    v_mfma_f32_32x32x16_bf16 v[16:31], v[76:79], v[60:63], v[16:31]
    ds_read_b128 v[56:59], v7 offset:16384
    ds_read_b64_tr_b16 v[72:73], v9 offset:22528
    ds_read_b64_tr_b16 v[74:75], v9 offset:22784
    s_waitcnt lgkmcnt(6)
    v_mfma_f32_32x32x16_bf16 v[16:31], v[64:67], v[48:51], v[16:31]
    ds_read_b128 v[60:63], v8 offset:16384
    ds_read_b64_tr_b16 v[76:77], v9 offset:23552
    ds_read_b64_tr_b16 v[78:79], v9 offset:23808
    s_waitcnt lgkmcnt(6)
    v_mfma_f32_32x32x16_bf16 v[16:31], v[68:71], v[52:55], v[16:31]
    s_barrier
    ds_read_b128 v[48:51], v5 offset:32768
    ds_read_b64_tr_b16 v[64:65], v9 offset:24576
    ds_read_b64_tr_b16 v[66:67], v9 offset:24832
    ds_read_b128 v[52:55], v6 offset:32768
    ds_read_b64_tr_b16 v[68:69], v9 offset:25600
    ds_read_b64_tr_b16 v[70:71], v9 offset:25856
    s_waitcnt lgkmcnt(9)
    v_mfma_f32_32x32x16_bf16 v[16:31], v[72:75], v[56:59], v[16:31]
    s_waitcnt lgkmcnt(6)
    v_mfma_f32_32x32x16_bf16 v[16:31], v[76:79], v[60:63], v[16:31]
    ds_read_b128 v[56:59], v7 offset:32768
    ds_read_b64_tr_b16 v[72:73], v9 offset:26624
    ds_read_b64_tr_b16 v[74:75], v9 offset:26880
    s_waitcnt lgkmcnt(6)
    v_mfma_f32_32x32x16_bf16 v[16:31], v[64:67], v[48:51], v[16:31]
    ds_read_b128 v[60:63], v8 offset:32768
    ds_read_b64_tr_b16 v[76:77], v9 offset:27648
    ds_read_b64_tr_b16 v[78:79], v9 offset:27904
    s_waitcnt lgkmcnt(6)
    v_mfma_f32_32x32x16_bf16 v[16:31], v[68:71], v[52:55], v[16:31]
    s_barrier
    v_mov_b32 v136, 0
    ds_read_b32 v122, v136
    ds_read_b128 v[48:51], v5 offset:49152
    ds_read_b64_tr_b16 v[64:65], v9 offset:28672
    ds_read_b64_tr_b16 v[66:67], v9 offset:28928
    ds_read_b128 v[52:55], v6 offset:49152
    ds_read_b64_tr_b16 v[68:69], v9 offset:29696
    ds_read_b64_tr_b16 v[70:71], v9 offset:29952
    s_waitcnt lgkmcnt(10)
    v_mfma_f32_32x32x16_bf16 v[16:31], v[72:75], v[56:59], v[16:31]
    s_waitcnt lgkmcnt(7)
    v_mfma_f32_32x32x16_bf16 v[16:31], v[76:79], v[60:63], v[16:31]
    ds_read_b128 v[56:59], v7 offset:49152
    ds_read_b64_tr_b16 v[72:73], v9 offset:30720
    ds_read_b64_tr_b16 v[74:75], v9 offset:30976
    s_waitcnt lgkmcnt(6)
    v_mfma_f32_32x32x16_bf16 v[16:31], v[64:67], v[48:51], v[16:31]
    ds_read_b128 v[60:63], v8 offset:49152
    ds_read_b64_tr_b16 v[76:77], v9 offset:31744
    ds_read_b64_tr_b16 v[78:79], v9 offset:32000
    s_waitcnt lgkmcnt(6)
    v_mfma_f32_32x32x16_bf16 v[16:31], v[68:71], v[52:55], v[16:31]
    v_readfirstlane_b32 s3, v122
    s_waitcnt lgkmcnt(3)
    v_mfma_f32_32x32x16_bf16 v[16:31], v[72:75], v[56:59], v[16:31]
    s_waitcnt lgkmcnt(0)
    v_mfma_f32_32x32x16_bf16 v[16:31], v[76:79], v[60:63], v[16:31]
    s_barrier
    s_lshl_b32 s56, s68, 14
    s_lshr_b32 s7, s4, 2
    s_lshl_b32 s58, s7, 13
    s_and_b32 s7, s4, 3
    s_lshl_b32 s7, s7, 11
    s_add_u32 s58, s58, s7
    s_add_u32 s57, s56, s58
    s_add_u32 s56, s56, s7
    v_lshlrev_b32 v2, 4, v1
    v_add_u32 v3, s58, v2
    s_nop 0
    v_cvt_pk_bf16_f32 v100, v24, v25
    v_cvt_pk_bf16_f32 v101, v26, v27
    v_cvt_pk_bf16_f32 v102, v28, v29
    v_cvt_pk_bf16_f32 v103, v30, v31
    s_cmp_eq_u32 s3, 0
    s_cbranch_scc1 Lfar_43
    buffer_store_dwordx4 v[100:103], v2, s[16:19], s57 offen
    s_branch Ljoin_44
Lfar_43:
    buffer_store_dwordx4 v[100:103], v2, s[16:19], s57 offen sc1
Ljoin_44:
    ds_write_b128 v3, v[100:103] offset:0
    s_mov_b32 s7, 0x3eb8aa3b
    v_mul_f32 v16, s7, v16
    v_mul_f32 v17, s7, v17
    v_mul_f32 v18, s7, v18
    v_mul_f32 v19, s7, v19
    v_mul_f32 v20, s7, v20
    v_mul_f32 v21, s7, v21
    v_mul_f32 v22, s7, v22
    v_mul_f32 v23, s7, v23
    v_cvt_pk_bf16_f32 v96, v16, v17
    v_cvt_pk_bf16_f32 v97, v18, v19
    v_cvt_pk_bf16_f32 v98, v20, v21
    v_cvt_pk_bf16_f32 v99, v22, v23
Lqkv_join_32:
    s_waitcnt lgkmcnt(0)
    s_barrier
    ds_read_b128 v[12:15], v128 offset:0
    s_waitcnt lgkmcnt(0)
    v_mfma_f32_32x32x16_bf16 v[16:31], v[12:15], v[96:99], 0
    ds_read_b128 v[12:15], v128 offset:2048
    s_setprio 3
    s_waitcnt lgkmcnt(0)
    v_mfma_f32_32x32x16_bf16 v[32:47], v[12:15], v[96:99], 0
    ds_read_b128 v[12:15], v128 offset:4096
    s_nop 6
    v_exp_f32 v16, v16
    v_exp_f32 v17, v17
    v_exp_f32 v18, v18
    v_exp_f32 v19, v19
    v_exp_f32 v20, v20
    v_exp_f32 v21, v21
    v_exp_f32 v22, v22
    v_exp_f32 v23, v23
    v_cvt_pk_bf16_f32 v48, v16, v17
    v_cvt_pk_bf16_f32 v49, v18, v19
    v_cvt_pk_bf16_f32 v50, v20, v21
    v_cvt_pk_bf16_f32 v51, v22, v23
    v_exp_f32 v24, v24
    v_exp_f32 v25, v25
    s_mov_b64 exec, s[66:67]
    ds_read_b128 v[112:115], v129 offset:0
    ds_read_b128 v[116:119], v129 offset:512
    s_mov_b64 exec, -1
    v_exp_f32 v26, v26
    v_exp_f32 v27, v27
    v_exp_f32 v28, v28
    v_exp_f32 v29, v29
    v_exp_f32 v30, v30
    v_exp_f32 v31, v31
    v_cvt_pk_bf16_f32 v52, v24, v25
    v_cvt_pk_bf16_f32 v53, v26, v27
    v_cvt_pk_bf16_f32 v54, v28, v29
    v_cvt_pk_bf16_f32 v55, v30, v31
    s_waitcnt vmcnt(0)
    s_cmp_eq_u32 s3, 0
    s_cbranch_scc1 Lfar_46
    v_mov_b32 v122, s69
    v_mov_b32 v123, 0
    s_mov_b64 exec, 1
    buffer_store_dword v122, v123, s[16:19], s8 offen
    s_mov_b64 exec, -1
    s_branch Ljoin_47
Lfar_46:
    v_mov_b32 v122, s69
    v_mov_b32 v123, 0
    s_mov_b64 exec, 1
    buffer_store_dword v122, v123, s[16:19], s8 offen sc1
    s_mov_b64 exec, -1
Ljoin_47:
    s_setprio 2
    s_waitcnt lgkmcnt(2)
    v_mfma_f32_32x32x16_bf16 v[16:31], v[12:15], v[96:99], 0
    ds_read_b128 v[12:15], v128 offset:6144
    v_exp_f32 v32, v32
    v_exp_f32 v33, v33
    v_exp_f32 v34, v34
    v_exp_f32 v35, v35
    v_exp_f32 v36, v36
    v_exp_f32 v37, v37
    s_waitcnt lgkmcnt(2)
    v_mfma_f32_32x32x16_bf16 v[64:79], v[112:115], v[48:51], 0
    v_exp_f32 v38, v38
    v_exp_f32 v39, v39
    v_cvt_pk_bf16_f32 v56, v32, v33
    v_cvt_pk_bf16_f32 v57, v34, v35
    v_cvt_pk_bf16_f32 v58, v36, v37
    v_cvt_pk_bf16_f32 v59, v38, v39
    v_exp_f32 v40, v40
    v_exp_f32 v41, v41
    s_waitcnt lgkmcnt(1)
    v_mfma_f32_32x32x16_bf16 v[64:79], v[116:119], v[52:55], v[64:79]
    s_mov_b64 exec, s[66:67]
    ds_read_b128 v[112:115], v129 offset:2048
    ds_read_b128 v[116:119], v129 offset:2560
    s_mov_b64 exec, -1
    v_exp_f32 v42, v42
    v_exp_f32 v43, v43
    v_exp_f32 v44, v44
    v_exp_f32 v45, v45
    v_exp_f32 v46, v46
    v_exp_f32 v47, v47
    v_cvt_pk_bf16_f32 v60, v40, v41
    v_cvt_pk_bf16_f32 v61, v42, v43
    v_cvt_pk_bf16_f32 v62, v44, v45
    v_cvt_pk_bf16_f32 v63, v46, v47
    s_setprio 1
    s_waitcnt lgkmcnt(2)
    v_mfma_f32_32x32x16_bf16 v[32:47], v[12:15], v[96:99], 0
    v_exp_f32 v16, v16
    v_exp_f32 v17, v17
    v_exp_f32 v18, v18
    v_exp_f32 v19, v19
    v_exp_f32 v20, v20
    v_exp_f32 v21, v21
    s_waitcnt lgkmcnt(1)
    v_mfma_f32_32x32x16_bf16 v[64:79], v[112:115], v[56:59], v[64:79]
    v_exp_f32 v22, v22
    v_exp_f32 v23, v23
    v_cvt_pk_bf16_f32 v48, v16, v17
    v_cvt_pk_bf16_f32 v49, v18, v19
    v_cvt_pk_bf16_f32 v50, v20, v21
    v_cvt_pk_bf16_f32 v51, v22, v23
    v_exp_f32 v24, v24
    v_exp_f32 v25, v25
    s_waitcnt lgkmcnt(0)
    v_mfma_f32_32x32x16_bf16 v[64:79], v[116:119], v[60:63], v[64:79]
    s_mov_b64 exec, s[66:67]
    ds_read_b128 v[112:115], v129 offset:4096
    ds_read_b128 v[116:119], v129 offset:4608
    s_mov_b64 exec, -1
    v_exp_f32 v26, v26
    v_exp_f32 v27, v27
    v_exp_f32 v28, v28
    v_exp_f32 v29, v29
    v_exp_f32 v30, v30
    v_exp_f32 v31, v31
    v_cvt_pk_bf16_f32 v52, v24, v25
    v_cvt_pk_bf16_f32 v53, v26, v27
    v_cvt_pk_bf16_f32 v54, v28, v29
    v_cvt_pk_bf16_f32 v55, v30, v31
    v_lshlrev_b32 v133, 3, v1
    s_lshl_b32 s65, s5, 9
    s_add_u32 s65, s65, 13697024
    buffer_load_dwordx2 v[122:123], v133, s[16:19], s65 offen sc1
    s_setprio 0
    v_exp_f32 v32, v32
    v_exp_f32 v33, v33
    v_exp_f32 v34, v34
    v_exp_f32 v35, v35
    v_exp_f32 v36, v36
    v_exp_f32 v37, v37
    s_waitcnt lgkmcnt(1)
    v_mfma_f32_32x32x16_bf16 v[64:79], v[112:115], v[48:51], v[64:79]
    v_exp_f32 v38, v38
    v_exp_f32 v39, v39
    v_cvt_pk_bf16_f32 v56, v32, v33
    v_cvt_pk_bf16_f32 v57, v34, v35
    v_cvt_pk_bf16_f32 v58, v36, v37
    v_cvt_pk_bf16_f32 v59, v38, v39
    v_exp_f32 v40, v40
    v_exp_f32 v41, v41
    s_waitcnt lgkmcnt(0)
    v_mfma_f32_32x32x16_bf16 v[64:79], v[116:119], v[52:55], v[64:79]
    s_mov_b64 exec, s[66:67]
    ds_read_b128 v[112:115], v129 offset:6144
    ds_read_b128 v[116:119], v129 offset:6656
    s_mov_b64 exec, -1
    v_exp_f32 v42, v42
    v_exp_f32 v43, v43
    v_exp_f32 v44, v44
    v_exp_f32 v45, v45
    v_exp_f32 v46, v46
    v_exp_f32 v47, v47
    v_cvt_pk_bf16_f32 v60, v40, v41
    v_cvt_pk_bf16_f32 v61, v42, v43
    v_cvt_pk_bf16_f32 v62, v44, v45
    v_cvt_pk_bf16_f32 v63, v46, v47
    s_waitcnt vmcnt(0)
    v_cmp_ne_u32 vcc, s69, v122
    v_cmp_ne_u32 s[74:75], s69, v123
    s_nop 3
    s_or_b64 vcc, vcc, s[74:75]
    s_cbranch_vccz Lpolled_50
    s_mov_b32 s71, 40000
Lpoll_49:
    buffer_load_dwordx2 v[122:123], v133, s[16:19], s65 offen sc1
    s_waitcnt vmcnt(0)
    v_cmp_ne_u32 vcc, s69, v122
    v_cmp_ne_u32 s[74:75], s69, v123
    s_nop 3
    s_or_b64 vcc, vcc, s[74:75]
    s_cbranch_vccz Lpolled_50
    s_sub_u32 s71, s71, 1
    s_cmp_eq_u32 s71, 0
    s_cbranch_scc1 Lpolled_50
    s_sleep 1
    s_branch Lpoll_49
Lpolled_50:
    s_add_u32 s56, s6, 1
    s_and_b32 s56, s56, 15
    s_lshl_b32 s56, s56, 14
    s_add_u32 m0, s62, 16384
    s_add_u32 s56, s56, s63
    buffer_load_dwordx4 v134, s[16:19], s56 offen sc1 lds
    s_add_u32 s56, s6, 1
    s_and_b32 s56, s56, 15
    s_lshl_b32 s56, s56, 14
    s_add_u32 m0, s62, 17408
    s_add_u32 s56, s56, s63
    buffer_load_dwordx4 v135, s[16:19], s56 offen sc1 lds
    s_add_u32 s56, s6, 2
    s_and_b32 s56, s56, 15
    s_lshl_b32 s56, s56, 14
    s_add_u32 m0, s62, 32768
    s_add_u32 s56, s56, s63
    buffer_load_dwordx4 v134, s[16:19], s56 offen sc1 lds
    s_add_u32 s56, s6, 2
    s_and_b32 s56, s56, 15
    s_lshl_b32 s56, s56, 14
    s_add_u32 m0, s62, 33792
    s_add_u32 s56, s56, s63
    buffer_load_dwordx4 v135, s[16:19], s56 offen sc1 lds
    v_add_u32 v130, 16384, v128
    v_add_u32 v131, 32768, v128
    v_add_u32 v132, 16384, v129
    s_mov_b32 s71, 1
    s_add_u32 s12, s71, 3
    s_and_b32 s13, s12, 3
    s_lshl_b32 s13, s13, 14
    s_add_u32 s13, s13, s62
    s_add_u32 s12, s12, s6
    s_and_b32 s12, s12, 15
    s_lshl_b32 s12, s12, 14
    s_add_u32 s12, s12, s63
    s_waitcnt vmcnt(2)
    s_waitcnt lgkmcnt(0)
    s_barrier
    ds_read_b128 v[12:15], v130 offset:0
    s_add_u32 s56, s6, 3
    s_and_b32 s56, s56, 15
    s_lshl_b32 s56, s56, 14
    s_add_u32 m0, s62, 49152
    s_add_u32 s56, s56, s63
    buffer_load_dwordx4 v134, s[16:19], s56 offen sc1 lds
    s_add_u32 s56, s6, 3
    s_and_b32 s56, s56, 15
    s_lshl_b32 s56, s56, 14
    s_add_u32 m0, s62, 50176
    s_add_u32 s56, s56, s63
    buffer_load_dwordx4 v135, s[16:19], s56 offen sc1 lds
    s_waitcnt lgkmcnt(0)
    v_mfma_f32_32x32x16_bf16 v[16:31], v[12:15], v[96:99], 0
    ds_read_b128 v[12:15], v130 offset:2048
    s_waitcnt lgkmcnt(0)
    s_nop 7
.p2align 3
Lattn:
    s_setprio 1
    s_waitcnt lgkmcnt(2)
    v_mfma_f32_32x32x16_bf16 v[32:47], v[12:15], v[96:99], 0
    ds_read_b128 v[12:15], v130 offset:4096
    v_exp_f32 v16, v16
    v_exp_f32 v17, v17
    v_exp_f32 v18, v18
    v_exp_f32 v19, v19
    v_exp_f32 v20, v20
    v_exp_f32 v21, v21
    s_waitcnt lgkmcnt(2)
    v_mfma_f32_32x32x16_bf16 v[64:79], v[112:115], v[56:59], v[64:79]
    v_exp_f32 v22, v22
    v_exp_f32 v23, v23
    v_cvt_pk_bf16_f32 v48, v16, v17
    v_cvt_pk_bf16_f32 v49, v18, v19
    v_cvt_pk_bf16_f32 v50, v20, v21
    v_cvt_pk_bf16_f32 v51, v22, v23
    v_exp_f32 v24, v24
    v_exp_f32 v25, v25
    s_waitcnt lgkmcnt(1)
    v_mfma_f32_32x32x16_bf16 v[64:79], v[116:119], v[60:63], v[64:79]
    s_mov_b64 exec, s[66:67]
    ds_read_b128 v[112:115], v132 offset:0
    ds_read_b128 v[116:119], v132 offset:512
    s_mov_b64 exec, -1
    v_exp_f32 v26, v26
    v_exp_f32 v27, v27
    v_exp_f32 v28, v28
    v_exp_f32 v29, v29
    v_exp_f32 v30, v30
    v_exp_f32 v31, v31
    v_cvt_pk_bf16_f32 v52, v24, v25
    v_cvt_pk_bf16_f32 v53, v26, v27
    v_cvt_pk_bf16_f32 v54, v28, v29
    v_cvt_pk_bf16_f32 v55, v30, v31
    s_cmp_lt_u32 s71, 13
    s_cbranch_scc1 Lkvw_51
    s_waitcnt vmcnt(0)
Lkvw_51:
    s_waitcnt vmcnt(2)
    s_setprio 0
    s_waitcnt lgkmcnt(2)
    v_mfma_f32_32x32x16_bf16 v[16:31], v[12:15], v[96:99], 0
    ds_read_b128 v[12:15], v130 offset:6144
    v_exp_f32 v32, v32
    v_exp_f32 v33, v33
    v_exp_f32 v34, v34
    v_exp_f32 v35, v35
    v_exp_f32 v36, v36
    v_exp_f32 v37, v37
    s_waitcnt lgkmcnt(2)
    v_mfma_f32_32x32x16_bf16 v[64:79], v[112:115], v[48:51], v[64:79]
    v_exp_f32 v38, v38
    v_exp_f32 v39, v39
    v_cvt_pk_bf16_f32 v56, v32, v33
    v_cvt_pk_bf16_f32 v57, v34, v35
    v_cvt_pk_bf16_f32 v58, v36, v37
    v_cvt_pk_bf16_f32 v59, v38, v39
    v_exp_f32 v40, v40
    v_exp_f32 v41, v41
    s_waitcnt lgkmcnt(1)
    v_mfma_f32_32x32x16_bf16 v[64:79], v[116:119], v[52:55], v[64:79]
    s_mov_b64 exec, s[66:67]
    ds_read_b128 v[112:115], v132 offset:2048
    ds_read_b128 v[116:119], v132 offset:2560
    s_mov_b64 exec, -1
    v_exp_f32 v42, v42
    v_exp_f32 v43, v43
    v_exp_f32 v44, v44
    v_exp_f32 v45, v45
    v_exp_f32 v46, v46
    v_exp_f32 v47, v47
    v_cvt_pk_bf16_f32 v60, v40, v41
    v_cvt_pk_bf16_f32 v61, v42, v43
    v_cvt_pk_bf16_f32 v62, v44, v45
    v_cvt_pk_bf16_f32 v63, v46, v47
    s_barrier
    s_setprio 3
    s_waitcnt lgkmcnt(2)
    v_mfma_f32_32x32x16_bf16 v[32:47], v[12:15], v[96:99], 0
    ds_read_b128 v[12:15], v131 offset:0
    v_exp_f32 v16, v16
    v_exp_f32 v17, v17
    v_exp_f32 v18, v18
    v_exp_f32 v19, v19
    v_exp_f32 v20, v20
    v_exp_f32 v21, v21
    s_waitcnt lgkmcnt(2)
    v_mfma_f32_32x32x16_bf16 v[64:79], v[112:115], v[56:59], v[64:79]
    s_cmp_ge_u32 s71, 13
    s_cbranch_scc1 Lnokv_52
    s_add_u32 m0, s13, 0
    s_nop 0
    buffer_load_dwordx4 v134, s[16:19], s12 offen sc1 lds
Lnokv_52:
    v_exp_f32 v22, v22
    v_exp_f32 v23, v23
    v_cvt_pk_bf16_f32 v48, v16, v17
    v_cvt_pk_bf16_f32 v49, v18, v19
    v_cvt_pk_bf16_f32 v50, v20, v21
    v_cvt_pk_bf16_f32 v51, v22, v23
    v_exp_f32 v24, v24
    v_exp_f32 v25, v25
    s_waitcnt lgkmcnt(1)
    v_mfma_f32_32x32x16_bf16 v[64:79], v[116:119], v[60:63], v[64:79]
    s_mov_b64 exec, s[66:67]
    ds_read_b128 v[112:115], v132 offset:4096
    ds_read_b128 v[116:119], v132 offset:4608
    s_mov_b64 exec, -1
    v_exp_f32 v26, v26
    v_exp_f32 v27, v27
    v_exp_f32 v28, v28
    v_exp_f32 v29, v29
    v_exp_f32 v30, v30
    v_exp_f32 v31, v31
    v_cvt_pk_bf16_f32 v52, v24, v25
    v_cvt_pk_bf16_f32 v53, v26, v27
    v_cvt_pk_bf16_f32 v54, v28, v29
    v_cvt_pk_bf16_f32 v55, v30, v31
    s_setprio 2
    s_waitcnt lgkmcnt(2)
    v_mfma_f32_32x32x16_bf16 v[16:31], v[12:15], v[96:99], 0
    ds_read_b128 v[12:15], v131 offset:2048
    v_exp_f32 v32, v32
    v_exp_f32 v33, v33
    v_exp_f32 v34, v34
    v_exp_f32 v35, v35
    v_exp_f32 v36, v36
    v_exp_f32 v37, v37
    s_waitcnt lgkmcnt(2)
    v_mfma_f32_32x32x16_bf16 v[64:79], v[112:115], v[48:51], v[64:79]
    s_cmp_ge_u32 s71, 13
    s_cbranch_scc1 Lnokv_53
    s_add_u32 m0, s13, 1024
    s_nop 0
    buffer_load_dwordx4 v135, s[16:19], s12 offen sc1 lds
Lnokv_53:
    v_exp_f32 v38, v38
    v_exp_f32 v39, v39
    v_cvt_pk_bf16_f32 v56, v32, v33
    v_cvt_pk_bf16_f32 v57, v34, v35
    v_cvt_pk_bf16_f32 v58, v36, v37
    v_cvt_pk_bf16_f32 v59, v38, v39
    v_exp_f32 v40, v40
    v_exp_f32 v41, v41
    s_waitcnt lgkmcnt(1)
    v_mfma_f32_32x32x16_bf16 v[64:79], v[116:119], v[52:55], v[64:79]
    s_mov_b64 exec, s[66:67]
    ds_read_b128 v[112:115], v132 offset:6144
    ds_read_b128 v[116:119], v132 offset:6656
    s_mov_b64 exec, -1
    v_exp_f32 v42, v42
    v_exp_f32 v43, v43
    v_exp_f32 v44, v44
    v_exp_f32 v45, v45
    v_exp_f32 v46, v46
    v_exp_f32 v47, v47
    v_cvt_pk_bf16_f32 v60, v40, v41
    v_cvt_pk_bf16_f32 v61, v42, v43
    v_cvt_pk_bf16_f32 v62, v44, v45
    v_cvt_pk_bf16_f32 v63, v46, v47
    s_add_u32 s71, s71, 1
    s_add_u32 s12, s71, 3
    s_and_b32 s13, s12, 3
    s_lshl_b32 s13, s13, 14
    s_add_u32 s13, s13, s62
    s_add_u32 s12, s12, s6
    s_and_b32 s12, s12, 15
    s_lshl_b32 s12, s12, 14
    s_add_u32 s12, s12, s63
    s_and_b32 s56, s71, 3
    s_lshl_b32 s56, s56, 14
    s_add_u32 s57, s71, 1
    s_and_b32 s57, s57, 3
    s_lshl_b32 s57, s57, 14
    v_mov_b32 v130, v131
    v_add_u32 v131, s57, v128
    v_add_u32 v132, s56, v129
    s_cmp_lt_u32 s71, 16
    s_cbranch_scc1 Lattn
    s_waitcnt lgkmcnt(1)
    v_mfma_f32_32x32x16_bf16 v[64:79], v[112:115], v[56:59], v[64:79]
    s_waitcnt lgkmcnt(0)
    v_mfma_f32_32x32x16_bf16 v[64:79], v[116:119], v[60:63], v[64:79]
    s_setprio 0
    v_mov_b32 v2, 0x33800000
    v_mov_b32 v3, 0x53800000
    s_nop 8
    v_mul_f32 v4, 0, v64
    v_fma_f32 v4, v65, 0, v4
    v_fma_f32 v4, v66, 0, v4
    v_fma_f32 v4, v67, 0, v4
    v_fma_f32 v4, v68, 0, v4
    v_fma_f32 v4, v69, 0, v4
    v_fma_f32 v4, v70, 0, v4
    v_fma_f32 v4, v71, 0, v4
    v_cmp_nge_f32 s[72:73], v72, v2
    v_cmp_nle_f32 s[74:75], v72, v3
    v_cmp_u_f32 vcc, v4, v4
    s_nop 2
    s_or_b64 s[72:73], s[72:73], s[74:75]
    s_or_b64 s[72:73], s[72:73], vcc
    s_cmp_eq_u64 s[72:73], 0
    s_cbranch_scc1 Lfb_ok_54
    s_lshl_b32 s65, s5, 18
    s_lshr_b32 s7, s4, 2
    s_lshl_b32 s7, s7, 13
    s_add_u32 s65, s65, s7
    v_lshlrev_b32 v33, 4, v1
    v_and_b32 v2, 15, v1
    v_lshrrev_b32 v3, 5, v1
    v_lshlrev_b32 v3, 8, v3
    v_lshl_add_u32 v34, v2, 4, v3
    v_mov_b32 v32, 0xff800000
    s_mov_b32 s71, 0
Lfb_max_55:
    s_lshr_b32 s7, s71, 2
    s_lshl_b32 s7, s7, 14
    s_and_b32 s56, s71, 3
    s_lshl_b32 s56, s56, 11
    s_add_u32 s7, s7, s56
    s_add_u32 s7, s7, s65
    buffer_load_dwordx4 v[12:15], v33, s[16:19], s7 offen sc1
    s_waitcnt vmcnt(0)
    v_mfma_f32_32x32x16_bf16 v[16:31], v[12:15], v[96:99], 0
    s_nop 15
    v_max_f32 v32, v32, v16
    v_max_f32 v32, v32, v17
    v_max_f32 v32, v32, v18
    v_max_f32 v32, v32, v19
    v_max_f32 v32, v32, v20
    v_max_f32 v32, v32, v21
    v_max_f32 v32, v32, v22
    v_max_f32 v32, v32, v23
    v_max_f32 v32, v32, v24
    v_max_f32 v32, v32, v25
    v_max_f32 v32, v32, v26
    v_max_f32 v32, v32, v27
    v_max_f32 v32, v32, v28
    v_max_f32 v32, v32, v29
    v_max_f32 v32, v32, v30
    v_max_f32 v32, v32, v31
    s_add_u32 s71, s71, 1
    s_cmp_lt_u32 s71, 64
    s_cbranch_scc1 Lfb_max_55
    v_mov_b32 v2, v32
    s_nop 1
    v_permlane32_swap_b32 v32, v2
    v_max_f32 v32, v32, v2
    v_mov_b32 v64, 0
    v_mov_b32 v65, 0
    v_mov_b32 v66, 0
    v_mov_b32 v67, 0
    v_mov_b32 v68, 0
    v_mov_b32 v69, 0
    v_mov_b32 v70, 0
    v_mov_b32 v71, 0
    v_mov_b32 v72, 0
    v_mov_b32 v73, 0
    v_mov_b32 v74, 0
    v_mov_b32 v75, 0
    v_mov_b32 v76, 0
    v_mov_b32 v77, 0
    v_mov_b32 v78, 0
    v_mov_b32 v79, 0
    s_mov_b32 s71, 0
Lfb_acc_56:
    s_lshr_b32 s7, s71, 2
    s_lshl_b32 s7, s7, 14
    s_and_b32 s56, s71, 3
    s_lshl_b32 s56, s56, 11
    s_add_u32 s7, s7, s56
    s_add_u32 s7, s7, s65
    buffer_load_dwordx4 v[12:15], v33, s[16:19], s7 offen sc1
    s_mov_b64 exec, s[66:67]
    buffer_load_dwordx4 v[112:115], v34, s[16:19], s7 offen offset:1024 sc1
    buffer_load_dwordx4 v[116:119], v34, s[16:19], s7 offen offset:1536 sc1
    s_mov_b64 exec, -1
    s_waitcnt vmcnt(0)
    v_mfma_f32_32x32x16_bf16 v[16:31], v[12:15], v[96:99], 0
    s_nop 15
    v_sub_f32 v16, v16, v32
    v_sub_f32 v17, v17, v32
    v_sub_f32 v18, v18, v32
    v_sub_f32 v19, v19, v32
    v_sub_f32 v20, v20, v32
    v_sub_f32 v21, v21, v32
    v_sub_f32 v22, v22, v32
    v_sub_f32 v23, v23, v32
    v_sub_f32 v24, v24, v32
    v_sub_f32 v25, v25, v32
    v_sub_f32 v26, v26, v32
    v_sub_f32 v27, v27, v32
    v_sub_f32 v28, v28, v32
    v_sub_f32 v29, v29, v32
    v_sub_f32 v30, v30, v32
    v_sub_f32 v31, v31, v32
    v_exp_f32 v16, v16
    v_exp_f32 v17, v17
    v_exp_f32 v18, v18
    v_exp_f32 v19, v19
    v_exp_f32 v20, v20
    v_exp_f32 v21, v21
    v_exp_f32 v22, v22
    v_exp_f32 v23, v23
    v_exp_f32 v24, v24
    v_exp_f32 v25, v25
    v_exp_f32 v26, v26
    v_exp_f32 v27, v27
    v_exp_f32 v28, v28
    v_exp_f32 v29, v29
    v_exp_f32 v30, v30
    v_exp_f32 v31, v31
    s_nop 1
    v_cvt_pk_bf16_f32 v48, v16, v17
    v_cvt_pk_bf16_f32 v49, v18, v19
    v_cvt_pk_bf16_f32 v50, v20, v21
    v_cvt_pk_bf16_f32 v51, v22, v23
    v_cvt_pk_bf16_f32 v52, v24, v25
    v_cvt_pk_bf16_f32 v53, v26, v27
    v_cvt_pk_bf16_f32 v54, v28, v29
    v_cvt_pk_bf16_f32 v55, v30, v31
    s_nop 1
    v_mfma_f32_32x32x16_bf16 v[64:79], v[112:115], v[48:51], v[64:79]
    v_mfma_f32_32x32x16_bf16 v[64:79], v[116:119], v[52:55], v[64:79]
    s_add_u32 s71, s71, 1
    s_cmp_lt_u32 s71, 64
    s_nop 15
    s_cbranch_scc1 Lfb_acc_56
    s_nop 15
Lfb_ok_54:
    v_rcp_f32 v2, v72
    s_nop 0
    v_mul_f32 v64, v64, v2
    v_mul_f32 v65, v65, v2
    v_mul_f32 v66, v66, v2
    v_mul_f32 v67, v67, v2
    v_mul_f32 v68, v68, v2
    v_mul_f32 v69, v69, v2
    v_mul_f32 v70, v70, v2
    v_mul_f32 v71, v71, v2
    v_cvt_pk_bf16_f32 v80, v64, v65
    v_cvt_pk_bf16_f32 v81, v66, v67
    v_cvt_pk_bf16_f32 v82, v68, v69
    v_cvt_pk_bf16_f32 v83, v70, v71
    s_and_b32 s7, s4, 3
    s_lshl_b32 s56, s6, 2
    s_add_u32 s7, s7, s56
    s_lshl_b32 s7, s7, 15
    s_lshr_b32 s56, s4, 2
    s_lshl_b32 s57, s5, 1
    s_add_u32 s56, s56, s57
    s_lshl_b32 s56, s56, 10
    s_add_u32 s7, s7, s56
    s_add_u32 s7, s7, 6291456
    v_lshlrev_b32 v2, 4, v1
    buffer_store_dwordx4 v[80:83], v2, s[16:19], s7 offen sc1
    s_barrier
    s_mov_b32 s71, 40000
    s_barrier
    s_barrier
    buffer_load_dwordx4 v[16:19], v139, s[16:19], s9 offen offset:0 sc1
    buffer_load_dwordx4 v[20:23], v139, s[16:19], s9 offen offset:1024 sc1
    buffer_load_dwordx4 v[24:27], v139, s[16:19], s9 offen offset:2048 sc1
    buffer_load_dwordx4 v[28:31], v139, s[16:19], s9 offen offset:3072 sc1
    buffer_load_dwordx4 v[32:35], v139, s[16:19], s10 offen offset:0 sc1
    buffer_load_dwordx4 v[36:39], v139, s[16:19], s10 offen offset:1024 sc1
    buffer_load_dwordx4 v[40:43], v139, s[16:19], s10 offen offset:2048 sc1
    buffer_load_dwordx4 v[44:47], v139, s[16:19], s10 offen offset:3072 sc1
    s_barrier
    s_branch Lochk_59
Lofull_57:
    s_waitcnt vmcnt(7)
    buffer_load_dwordx4 v[16:19], v139, s[16:19], s9 offen offset:0 sc1
    s_waitcnt vmcnt(7)
    buffer_load_dwordx4 v[20:23], v139, s[16:19], s9 offen offset:1024 sc1
    s_waitcnt vmcnt(7)
    buffer_load_dwordx4 v[24:27], v139, s[16:19], s9 offen offset:2048 sc1
    s_waitcnt vmcnt(7)
    buffer_load_dwordx4 v[28:31], v139, s[16:19], s9 offen offset:3072 sc1
    s_waitcnt vmcnt(7)
    buffer_load_dwordx4 v[32:35], v139, s[16:19], s10 offen offset:0 sc1
    s_waitcnt vmcnt(7)
    buffer_load_dwordx4 v[36:39], v139, s[16:19], s10 offen offset:1024 sc1
    s_waitcnt vmcnt(7)
    buffer_load_dwordx4 v[40:43], v139, s[16:19], s10 offen offset:2048 sc1
    s_waitcnt vmcnt(7)
    buffer_load_dwordx4 v[44:47], v139, s[16:19], s10 offen offset:3072 sc1
Lochk_59:
    ds_read_b64_tr_b16 v[84:85], v137 offset:0
    ds_read_b64_tr_b16 v[86:87], v137 offset:512
    ds_read_b64_tr_b16 v[88:89], v138 offset:0
    ds_read_b64_tr_b16 v[90:91], v138 offset:512
    ds_read_b64_tr_b16 v[92:93], v137 offset:1024
    ds_read_b64_tr_b16 v[94:95], v137 offset:1536
    s_waitcnt vmcnt(7) lgkmcnt(4)
    v_mfma_f32_32x32x16_bf16 v[48:63], v[16:19], v[84:87], 0
    ds_read_b64_tr_b16 v[84:85], v138 offset:1024
    ds_read_b64_tr_b16 v[86:87], v138 offset:1536
    s_waitcnt lgkmcnt(4)
    v_mfma_f32_32x32x16_bf16 v[64:79], v[16:19], v[88:91], 0
    ds_read_b64_tr_b16 v[88:89], v137 offset:2048
    ds_read_b64_tr_b16 v[90:91], v137 offset:2560
    s_waitcnt vmcnt(6) lgkmcnt(4)
    v_mfma_f32_32x32x16_bf16 v[48:63], v[20:23], v[92:95], v[48:63]
    ds_read_b64_tr_b16 v[92:93], v138 offset:2048
    ds_read_b64_tr_b16 v[94:95], v138 offset:2560
    s_waitcnt lgkmcnt(4)
    v_mfma_f32_32x32x16_bf16 v[64:79], v[20:23], v[84:87], v[64:79]
    ds_read_b64_tr_b16 v[84:85], v137 offset:3072
    ds_read_b64_tr_b16 v[86:87], v137 offset:3584
    s_waitcnt vmcnt(5) lgkmcnt(4)
    v_mfma_f32_32x32x16_bf16 v[48:63], v[24:27], v[88:91], v[48:63]
    ds_read_b64_tr_b16 v[88:89], v138 offset:3072
    ds_read_b64_tr_b16 v[90:91], v138 offset:3584
    s_waitcnt lgkmcnt(4)
    v_mfma_f32_32x32x16_bf16 v[64:79], v[24:27], v[92:95], v[64:79]
    v_max3_u32 v143, v16, v20, v24
    ds_read_b64_tr_b16 v[92:93], v137 offset:4096
    ds_read_b64_tr_b16 v[94:95], v137 offset:4608
    s_waitcnt vmcnt(4) lgkmcnt(4)
    v_mfma_f32_32x32x16_bf16 v[48:63], v[28:31], v[84:87], v[48:63]
    ds_read_b64_tr_b16 v[84:85], v138 offset:4096
    ds_read_b64_tr_b16 v[86:87], v138 offset:4608
    s_waitcnt lgkmcnt(4)
    v_mfma_f32_32x32x16_bf16 v[64:79], v[28:31], v[88:91], v[64:79]
    ds_read_b64_tr_b16 v[88:89], v137 offset:5120
    ds_read_b64_tr_b16 v[90:91], v137 offset:5632
    s_waitcnt vmcnt(3) lgkmcnt(4)
    v_mfma_f32_32x32x16_bf16 v[48:63], v[32:35], v[92:95], v[48:63]
    ds_read_b64_tr_b16 v[92:93], v138 offset:5120
    ds_read_b64_tr_b16 v[94:95], v138 offset:5632
    s_waitcnt lgkmcnt(4)
    v_mfma_f32_32x32x16_bf16 v[64:79], v[32:35], v[84:87], v[64:79]
    v_max3_u32 v143, v143, v28, v32
    ds_read_b64_tr_b16 v[84:85], v137 offset:6144
    ds_read_b64_tr_b16 v[86:87], v137 offset:6656
    s_waitcnt vmcnt(2) lgkmcnt(4)
    v_mfma_f32_32x32x16_bf16 v[48:63], v[36:39], v[88:91], v[48:63]
    ds_read_b64_tr_b16 v[88:89], v138 offset:6144
    ds_read_b64_tr_b16 v[90:91], v138 offset:6656
    s_waitcnt lgkmcnt(4)
    v_mfma_f32_32x32x16_bf16 v[64:79], v[36:39], v[92:95], v[64:79]
    ds_read_b64_tr_b16 v[92:93], v137 offset:7168
    ds_read_b64_tr_b16 v[94:95], v137 offset:7680
    s_waitcnt vmcnt(1) lgkmcnt(4)
    v_mfma_f32_32x32x16_bf16 v[48:63], v[40:43], v[84:87], v[48:63]
    ds_read_b64_tr_b16 v[84:85], v138 offset:7168
    ds_read_b64_tr_b16 v[86:87], v138 offset:7680
    s_waitcnt lgkmcnt(4)
    v_mfma_f32_32x32x16_bf16 v[64:79], v[40:43], v[88:91], v[64:79]
    v_max3_u32 v143, v143, v36, v40
    s_waitcnt vmcnt(0) lgkmcnt(2)
    v_mfma_f32_32x32x16_bf16 v[48:63], v[44:47], v[92:95], v[48:63]
    v_max_u32 v143, v143, v44
    v_cmp_eq_u32 vcc, -1, v143
    s_waitcnt lgkmcnt(0)
    v_mfma_f32_32x32x16_bf16 v[64:79], v[44:47], v[84:87], v[64:79]
    s_nop 1
    s_cbranch_vccz Logot_58
    s_sub_u32 s71, s71, 1
    s_cmp_gt_i32 s71, 0
    s_cbranch_scc1 Lofull_57
Logot_58:
    s_nop 7
    s_nop 3
    s_lshr_b32 s58, s4, 1
    s_cmp_eq_u32 s58, 0
    s_cbranch_scc1 Lrw_60
    ds_write_b128 v140, v[48:51] offset:0
    ds_write_b128 v140, v[52:55] offset:1024
Lrw_60:
    s_cmp_eq_u32 s58, 1
    s_cbranch_scc1 Lrw_61
    ds_write_b128 v140, v[56:59] offset:8192
    ds_write_b128 v140, v[60:63] offset:9216
Lrw_61:
    s_cmp_eq_u32 s58, 2
    s_cbranch_scc1 Lrw_62
    ds_write_b128 v140, v[64:67] offset:16384
    ds_write_b128 v140, v[68:71] offset:17408
Lrw_62:
    s_cmp_eq_u32 s58, 3
    s_cbranch_scc1 Lrw_63
    ds_write_b128 v140, v[72:75] offset:24576
    ds_write_b128 v140, v[76:79] offset:25600
Lrw_63:
    s_waitcnt lgkmcnt(0)
    s_barrier
    s_cmp_eq_u32 s58, 0
    s_cbranch_scc1 Lro_64
    ds_read_b128 v[16:19], v141 offset:0
    ds_read_b128 v[20:23], v141 offset:1024
    s_branch Lrn_65
Lro_64:
    v_mov_b32 v16, v48
    v_mov_b32 v17, v49
    v_mov_b32 v18, v50
    v_mov_b32 v19, v51
    v_mov_b32 v20, v52
    v_mov_b32 v21, v53
    v_mov_b32 v22, v54
    v_mov_b32 v23, v55
Lrn_65:
    s_cmp_eq_u32 s58, 1
    s_cbranch_scc1 Lro_66
    ds_read_b128 v[24:27], v141 offset:2048
    ds_read_b128 v[28:31], v141 offset:3072
    s_branch Lrn_67
Lro_66:
    v_mov_b32 v24, v56
    v_mov_b32 v25, v57
    v_mov_b32 v26, v58
    v_mov_b32 v27, v59
    v_mov_b32 v28, v60
    v_mov_b32 v29, v61
    v_mov_b32 v30, v62
    v_mov_b32 v31, v63
Lrn_67:
    s_cmp_eq_u32 s58, 2
    s_cbranch_scc1 Lro_68
    ds_read_b128 v[32:35], v141 offset:4096
    ds_read_b128 v[36:39], v141 offset:5120
    s_branch Lrn_69
Lro_68:
    v_mov_b32 v32, v64
    v_mov_b32 v33, v65
    v_mov_b32 v34, v66
    v_mov_b32 v35, v67
    v_mov_b32 v36, v68
    v_mov_b32 v37, v69
    v_mov_b32 v38, v70
    v_mov_b32 v39, v71
Lrn_69:
    s_cmp_eq_u32 s58, 3
    s_cbranch_scc1 Lro_70
    ds_read_b128 v[40:43], v141 offset:6144
    ds_read_b128 v[44:47], v141 offset:7168
    s_branch Lrn_71
Lro_70:
    v_mov_b32 v40, v72
    v_mov_b32 v41, v73
    v_mov_b32 v42, v74
    v_mov_b32 v43, v75
    v_mov_b32 v44, v76
    v_mov_b32 v45, v77
    v_mov_b32 v46, v78
    v_mov_b32 v47, v79
Lrn_71:
    s_waitcnt lgkmcnt(0)
    v_add_f32 v16, v16, v24
    v_add_f32 v17, v17, v25
    v_add_f32 v18, v18, v26
    v_add_f32 v19, v19, v27
    v_add_f32 v20, v20, v28
    v_add_f32 v21, v21, v29
    v_add_f32 v22, v22, v30
    v_add_f32 v23, v23, v31
    v_add_f32 v32, v32, v40
    v_add_f32 v33, v33, v41
    v_add_f32 v34, v34, v42
    v_add_f32 v35, v35, v43
    v_add_f32 v36, v36, v44
    v_add_f32 v37, v37, v45
    v_add_f32 v38, v38, v46
    v_add_f32 v39, v39, v47
    v_add_f32 v16, v16, v32
    s_add_u32 s56, s11, 0
    buffer_store_dword v16, v142, s[20:23], s56 offen sc1
    v_add_f32 v17, v17, v33
    s_add_u32 s56, s11, 4096
    buffer_store_dword v17, v142, s[20:23], s56 offen sc1
    v_add_f32 v18, v18, v34
    s_add_u32 s56, s11, 8192
    buffer_store_dword v18, v142, s[20:23], s56 offen sc1
    v_add_f32 v19, v19, v35
    s_add_u32 s56, s11, 12288
    buffer_store_dword v19, v142, s[20:23], s56 offen sc1
    v_add_f32 v20, v20, v36
    s_add_u32 s56, s11, 32768
    buffer_store_dword v20, v142, s[20:23], s56 offen sc1
    v_add_f32 v21, v21, v37
    s_add_u32 s56, s11, 36864
    buffer_store_dword v21, v142, s[20:23], s56 offen sc1
    v_add_f32 v22, v22, v38
    s_add_u32 s56, s11, 40960
    buffer_store_dword v22, v142, s[20:23], s56 offen sc1
    v_add_f32 v23, v23, v39
    s_add_u32 s56, s11, 45056
    buffer_store_dword v23, v142, s[20:23], s56 offen sc1
Lexit:
    s_endpgm
Lcodeend:
.section .rodata,"a"
.p2align 6
.amdhsa_kernel concat_heads__softmax_full_mha__ssm_conv_s5__prompt_kernel
  .amdhsa_next_free_vgpr 168
  .amdhsa_next_free_sgpr 102
  .amdhsa_accum_offset 168
  .amdhsa_group_segment_fixed_size 0
  .amdhsa_kernarg_size 120
  .amdhsa_user_sgpr_count 2
  .amdhsa_user_sgpr_kernarg_segment_ptr 1
  .amdhsa_system_sgpr_workgroup_id_x 1
  .amdhsa_float_denorm_mode_32 3
.end_amdhsa_kernel
```
